```python
import torch

def _softmax(x, axis=-1):
    return torch.softmax(x, dim=axis)
def _gelu(x):
    return torch.nn.functional.gelu(x, approximate="tanh")
def _silu(x):
    return torch.nn.functional.silu(x)
def _sigmoid(x):
    return torch.sigmoid(x)
def _layernorm(x, axis=-1, eps=1e-5):
    m = x.mean(dim=axis, keepdim=True)
    v = x.var(dim=axis, keepdim=True, unbiased=False)
    return (x - m) / torch.sqrt(v + eps)
def _scatter_add(tgt, idx, src, axis=0):
    return tgt.clone().index_add_(axis, idx, src)
def _segment_sum(src, seg, n):
    out = torch.zeros((n,) + src.shape[1:], dtype=src.dtype)
    return out.index_add_(0, seg, src)
def _pad(x, pw):
    flat = tuple(v for pair in reversed(pw) for v in pair)
    return torch.nn.functional.pad(x, flat)

kernel_name = 'interleave_layers__gqa_block_cached__dense_activation_silu__decode'

def setup_inputs():

    _w = (lambda a: (lambda t: t.to(torch.bfloat16) if t.is_floating_point() else t)(torch.as_tensor(a)))
    def _A_setup():
        B, Sq, D = 8, 1, 512
        Hq, Hkv, Sk, Dh = 32, 32, 4096, 128
        assert Hq % Hkv == 0, (Hq, Hkv)
        return {
            "x": _w((lambda *s: torch.randn(*s, dtype=torch.bfloat16) * 0.1)(B, Sq, D)),
            "k_cache": _w((lambda *s: torch.randn(*s, dtype=torch.bfloat16) * 0.8)(B, Hkv, Sk, Dh)),
            "v_cache": _w((lambda *s: torch.randn(*s, dtype=torch.bfloat16) * 1.6)(B, Hkv, Sk, Dh)),
            "wq": _w((lambda *s: torch.randn(*s, dtype=torch.bfloat16) * 0.8)(D, Hq * Dh) * (D ** -0.5)),
            "wo": _w((lambda *s: torch.randn(*s, dtype=torch.bfloat16) * 1.6)(Hq * Dh, D) * ((Hq * Dh) ** -0.5)),
        }
    _A_in = _A_setup()

    def _B_setup():
        B, S, D, F = 8, 1, 512, 1376
        return {
            "x": _w((lambda *s: torch.randn(*s, dtype=torch.bfloat16) * 0.1)(B, S, D)),
            "w1": _w((lambda *s: torch.randn(*s, dtype=torch.bfloat16) * 0.4)(D, F) * (D ** -0.5)),
            "w2": _w((lambda *s: torch.randn(*s, dtype=torch.bfloat16) * 0.4)(F, D) * (F ** -0.5)),
        }
    _B_in = _B_setup()

    return {
        "A_x": _A_in["x"],
        "A_k_cache": _A_in["k_cache"],
        "A_v_cache": _A_in["v_cache"],
        "A_wq": _A_in["wq"],
        "A_wo": _A_in["wo"],
        "B_x": _B_in["x"],
        "B_w1": _B_in["w1"],
        "B_w2": _B_in["w2"],
    }

def reference(A_x, A_k_cache, A_v_cache, A_wq, A_wo, B_x, B_w1, B_w2):
    def _A_ref(x, k_cache, v_cache, wq, wo):
        B, Sq, D = x.shape
        Hq, Dh = 32, 128
        Hkv = k_cache.shape[1]
        rep = Hq // Hkv
        q = (lambda x, *d: x.permute(*d))((x @ wq).reshape(B, Sq, Hq, Dh), 0, 2, 1, 3)
        k = (lambda x, n, axis: torch.repeat_interleave(x, n, dim=axis))(k_cache, rep, axis=1)
        v = (lambda x, n, axis: torch.repeat_interleave(x, n, dim=axis))(v_cache, rep, axis=1)
        scores = torch.einsum("bhqd,bhkd->bhqk", q, k) * (Dh ** -0.5)
        p = _softmax(scores, axis=-1)
        o = torch.einsum("bhqk,bhkd->bhqd", p, v)
        return (lambda x, *d: x.permute(*d))(o, 0, 2, 1, 3).reshape(B, Sq, Hq * Dh) @ wo

    def _B_ref(x, w1, w2):
        h = torch.einsum("bsd,df->bsf", x, w1)
        h = _silu(h)
        out = torch.einsum("bsf,fd->bsd", h, w2)
        return out

    x = A_x
    x = x + _A_ref(_layernorm(x, axis=-1), A_k_cache, A_v_cache, A_wq, A_wo)
    x = x + _B_ref(_layernorm(x, axis=-1), B_w1, B_w2)
    x = x + _A_ref(_layernorm(x, axis=-1), A_k_cache, A_v_cache, A_wq, A_wo)
    x = x + _B_ref(_layernorm(x, axis=-1), B_w1, B_w2)
    return x
```

```asm
; @launch grid=(256,1,1) block=(512,1,1) lds=163840
.amdgcn_target "amdgcn-amd-amdhsa--gfx950"
.text
.globl interleave_layers__gqa_block_cached__dense_activation_silu__decode_kernel
.p2align 8
.type interleave_layers__gqa_block_cached__dense_activation_silu__decode_kernel,@function
interleave_layers__gqa_block_cached__dense_activation_silu__decode_kernel:
    s_cmp_ge_u32 s2, 256
    s_cbranch_scc1 main_end
    s_load_dwordx4 s[64:67], s[0:1], 8
    s_load_dwordx2 s[68:69], s[0:1], 0
    s_load_dwordx4 s[72:75], s[0:1], 24
    s_load_dwordx4 s[76:79], s[0:1], 48
    s_load_dwordx2 s[80:81], s[0:1], 64
    s_load_dwordx2 s[82:83], s[0:1], 80
    s_load_dwordx2 s[70:71], s[0:1], 72
    v_lshrrev_b32 v2, 6, v0
    s_nop 0
    v_readfirstlane_b32 s24, v2
    v_and_b32 v3, 63, v0
    v_lshlrev_b32 v0, 4, v3
    s_and_b32 s25, s24, 3
    s_lshr_b32 s26, s24, 2
    s_mul_i32 s52, s24, 7168
    v_add_u32 v1, s52, v0
    s_mov_b32 s31, 400000
    s_waitcnt lgkmcnt(0)
    s_mov_b32 s4, s64
    s_and_b32 s5, s65, 0xffff
    s_mov_b32 s6, 0x10000000
    s_mov_b32 s7, 0x00020000
    s_mov_b32 s8, s66
    s_and_b32 s9, s67, 0xffff
    s_mov_b32 s10, 0x10000000
    s_mov_b32 s11, 0x00020000
    s_mov_b32 s12, s82
    s_and_b32 s13, s83, 0xffff
    s_mov_b32 s14, 0x40000000
    s_mov_b32 s15, 0x00020000
    s_mov_b32 s16, s68
    s_and_b32 s17, s69, 0xffff
    s_mov_b32 s18, 0x2000
    s_mov_b32 s19, 0x00020000
    s_mov_b32 s56, s80
    s_and_b32 s57, s81, 0xffff
    s_mov_b32 s58, 0x2000
    s_mov_b32 s59, 0x00020000
    s_mov_b32 s92, s70
    s_and_b32 s93, s71, 0xffff
    s_mov_b32 s94, 0x100
    s_mov_b32 s95, 0x00020000
    s_getreg_b32 s96, hwreg(HW_REG_XCC_ID)
    s_and_b32 s96, s96, 7
    s_cmp_lg_u32 s24, 0
    s_cbranch_scc1 norole_1
    v_mov_b32 v4, 1
    s_lshl_b32 s32, s96, 2
    v_mov_b32 v5, s32
    s_mov_b64 exec, 1
    buffer_atomic_add v4, v5, s[92:95], 0 offen offset:64 sc0 sc1
    s_waitcnt vmcnt(0)
    v_mov_b32 v5, 162560
    ds_write_b32 v5, v4
    s_waitcnt lgkmcnt(0)
    s_mov_b64 exec, -1
norole_1:
    s_nop 3
    s_barrier
    v_mov_b32 v5, 162560
    ds_read_b32 v4, v5
    s_waitcnt lgkmcnt(0)
    v_readfirstlane_b32 s32, v4
    s_lshr_b32 s98, s32, 5
    s_add_u32 s98, s98, 1
    s_lshl_b32 s98, s98, 7
    s_and_b32 s32, s32, 31
    s_and_b32 s20, s32, 1
    s_lshr_b32 s97, s32, 1
    s_lshl_b32 s21, s96, 4
    s_add_u32 s21, s21, s97
    s_lshr_b32 s22, s21, 2
    s_and_b32 s23, s21, 3
    s_lshl_b32 s39, s21, 18
    s_lshl_b32 s34, s24, 15
    s_add_u32 s39, s39, s34
    s_mov_b32 s84, 0x05040100
    s_mov_b32 s85, 0x07060302
    s_mov_b32 s27, 0
    s_mov_b32 s60, s74
    s_and_b32 s61, s75, 0xffff
    s_mov_b32 s62, 0x400000
    s_mov_b32 s63, 0x00020000
    v_lshrrev_b32 v4, 2, v3
    v_lshlrev_b32 v4, 11, v4
    v_and_b32 v5, 3, v3
    v_lshl_add_u32 v4, v5, 4, v4
    s_lshl_b32 s32, s96, 19
    s_lshl_b32 s33, s97, 6
    s_add_u32 s32, s32, s33
    s_lshl_b32 s33, s24, 16
    s_add_u32 s32, s32, s33
    buffer_load_dwordx4 v[124:127], v4, s[60:63], s32 offen offset:0
    buffer_load_dwordx4 v[128:131], v4, s[60:63], s32 offen offset:1024
    s_add_u32 s32, s32, 32768
    buffer_load_dwordx4 v[132:135], v4, s[60:63], s32 offen offset:0
    buffer_load_dwordx4 v[136:139], v4, s[60:63], s32 offen offset:1024
    s_mov_b32 s60, s72
    s_and_b32 s61, s73, 0xffff
    s_mov_b32 s62, 0x400000
    s_mov_b32 s63, 0x00020000
    v_lshrrev_b32 v4, 2, v3
    v_lshlrev_b32 v4, 14, v4
    v_and_b32 v5, 3, v3
    v_lshl_add_u32 v4, v5, 4, v4
    s_lshl_b32 s32, s21, 6
    s_lshl_b32 s33, s24, 19
    s_add_u32 s32, s32, s33
    buffer_load_dwordx4 v[140:143], v4, s[60:63], s32 offen
    s_add_u32 s32, s32, 8192
    buffer_load_dwordx4 v[144:147], v4, s[60:63], s32 offen
    s_add_u32 s32, s32, 253952
    buffer_load_dwordx4 v[148:151], v4, s[60:63], s32 offen
    s_add_u32 s32, s32, 8192
    buffer_load_dwordx4 v[152:155], v4, s[60:63], s32 offen
    s_cmp_eq_u32 s26, 1
    s_cbranch_scc1 ld_w2_2
    s_mov_b32 s60, s76
    s_and_b32 s61, s77, 0xffff
    s_mov_b32 s62, 0x158000
    s_mov_b32 s63, 0x00020000
    s_movk_i32 s33, 22016
    v_mul_lo_u32 v4, s33, v3
    s_mul_i32 s32, s21, 24
    s_mul_i32 s33, s25, 5504
    s_add_u32 s32, s32, s33
    buffer_load_dwordx2 v[16:17], v4, s[60:63], s32 offen offset:0
    buffer_load_dwordx2 v[18:19], v4, s[60:63], s32 offen offset:8
    buffer_load_dwordx2 v[20:21], v4, s[60:63], s32 offen offset:16
    buffer_load_dwordx2 v[22:23], v4, s[60:63], s32 offen offset:2752
    buffer_load_dwordx2 v[24:25], v4, s[60:63], s32 offen offset:2760
    buffer_load_dwordx2 v[26:27], v4, s[60:63], s32 offen offset:2768
    s_branch ld_wdone_3
ld_w2_2:
    s_nop 3
    s_mov_b32 s60, s78
    s_and_b32 s61, s79, 0xffff
    s_mov_b32 s62, 0x158000
    s_mov_b32 s63, 0x00020000
    v_lshlrev_b32 v4, 2, v3
    s_mul_i32 s32, s21, 12288
    s_lshl_b32 s33, s25, 8
    s_add_u32 s32, s32, s33
    buffer_load_dword v16, v4, s[60:63], s32 offen offset:0
    buffer_load_dword v17, v4, s[60:63], s32 offen offset:1024
    buffer_load_dword v18, v4, s[60:63], s32 offen offset:2048
    buffer_load_dword v19, v4, s[60:63], s32 offen offset:3072
    s_add_u32 s32, s32, 4096
    buffer_load_dword v20, v4, s[60:63], s32 offen offset:0
    buffer_load_dword v21, v4, s[60:63], s32 offen offset:1024
    buffer_load_dword v22, v4, s[60:63], s32 offen offset:2048
    buffer_load_dword v23, v4, s[60:63], s32 offen offset:3072
    s_add_u32 s32, s32, 4096
    buffer_load_dword v24, v4, s[60:63], s32 offen offset:0
    buffer_load_dword v25, v4, s[60:63], s32 offen offset:1024
    buffer_load_dword v26, v4, s[60:63], s32 offen offset:2048
    buffer_load_dword v27, v4, s[60:63], s32 offen offset:3072
ld_wdone_3:
    s_nop 3
    s_barrier
    s_cmp_eq_u32 s20, 0
    s_cbranch_scc1 g0skip_4
    s_waitcnt vmcnt(0)
    v_lshrrev_b32 v7, 6, v0
    v_and_b32 v8, 3, v7
    v_lshrrev_b32 v7, 2, v7
    v_lshlrev_b32 v7, 4, v7
    v_lshl_add_u32 v7, v8, 13, v7
    v_bfe_u32 v8, v0, 4, 2
    v_lshl_add_u32 v7, v8, 10, v7
    s_lshl_b32 s32, s24, 7
    s_add_u32 s32, s32, 57344
    v_add_u32 v7, s32, v7
    v_perm_b32 v8, v128, v124, s84
    v_perm_b32 v9, v128, v124, s85
    v_perm_b32 v10, v129, v125, s84
    v_perm_b32 v11, v129, v125, s85
    ds_write_b128 v7, v[8:11] offset:0
    v_perm_b32 v8, v130, v126, s84
    v_perm_b32 v9, v130, v126, s85
    v_perm_b32 v10, v131, v127, s84
    v_perm_b32 v11, v131, v127, s85
    ds_write_b128 v7, v[8:11] offset:4096
    v_perm_b32 v8, v136, v132, s84
    v_perm_b32 v9, v136, v132, s85
    v_perm_b32 v10, v137, v133, s84
    v_perm_b32 v11, v137, v133, s85
    ds_write_b128 v7, v[8:11] offset:64
    v_perm_b32 v8, v138, v134, s84
    v_perm_b32 v9, v138, v134, s85
    v_perm_b32 v10, v139, v135, s84
    v_perm_b32 v11, v139, v135, s85
    ds_write_b128 v7, v[8:11] offset:4160
    v_lshrrev_b32 v7, 6, v0
    v_and_b32 v8, 3, v7
    v_lshrrev_b32 v7, 2, v7
    v_lshlrev_b32 v7, 4, v7
    v_lshl_add_u32 v7, v8, 13, v7
    v_bfe_u32 v8, v0, 4, 2
    v_lshl_add_u32 v7, v8, 11, v7
    s_lshl_b32 s32, s24, 7
    s_add_u32 s32, s32, 90112
    v_add_u32 v7, s32, v7
    v_perm_b32 v8, v144, v140, s84
    v_perm_b32 v9, v144, v140, s85
    v_perm_b32 v10, v145, v141, s84
    v_perm_b32 v11, v145, v141, s85
    ds_write_b128 v7, v[8:11] offset:0
    v_perm_b32 v8, v146, v142, s84
    v_perm_b32 v9, v146, v142, s85
    v_perm_b32 v10, v147, v143, s84
    v_perm_b32 v11, v147, v143, s85
    ds_write_b128 v7, v[8:11] offset:1024
    v_perm_b32 v8, v152, v148, s84
    v_perm_b32 v9, v152, v148, s85
    v_perm_b32 v10, v153, v149, s84
    v_perm_b32 v11, v153, v149, s85
    ds_write_b128 v7, v[8:11] offset:64
    v_perm_b32 v8, v154, v150, s84
    v_perm_b32 v9, v154, v150, s85
    v_perm_b32 v10, v155, v151, s84
    v_perm_b32 v11, v155, v151, s85
    ds_write_b128 v7, v[8:11] offset:1088
    s_cmp_eq_u32 s26, 1
    s_cbranch_scc1 pm_w2_5
    s_cmp_lg_u32 s21, 114
    s_cbranch_scc1 nomask_7
    v_mov_b32 v20, 0
    v_mov_b32 v21, 0
    v_mov_b32 v26, 0
    v_mov_b32 v27, 0
nomask_7:
    s_nop 3
    s_mul_i32 s32, s25, 3072
    s_add_u32 s32, s32, 122880
    v_add_u32 v7, s32, v0
    v_perm_b32 v8, v22, v16, s84
    v_perm_b32 v9, v22, v16, s85
    v_perm_b32 v10, v23, v17, s84
    v_perm_b32 v11, v23, v17, s85
    ds_write_b128 v7, v[8:11] offset:0
    v_perm_b32 v8, v24, v18, s84
    v_perm_b32 v9, v24, v18, s85
    v_perm_b32 v10, v25, v19, s84
    v_perm_b32 v11, v25, v19, s85
    ds_write_b128 v7, v[8:11] offset:1024
    v_perm_b32 v8, v26, v20, s84
    v_perm_b32 v9, v26, v20, s85
    v_perm_b32 v10, v27, v21, s84
    v_perm_b32 v11, v27, v21, s85
    ds_write_b128 v7, v[8:11] offset:2048
    s_branch pm_done_6
pm_w2_5:
    s_nop 3
    s_lshl_b32 s32, s25, 10
    s_add_u32 s32, s32, 135168
    v_add_u32 v7, s32, v0
    v_perm_b32 v8, v17, v16, s84
    v_perm_b32 v9, v17, v16, s85
    v_perm_b32 v10, v19, v18, s84
    v_perm_b32 v11, v19, v18, s85
    ds_write_b128 v7, v[8:11] offset:0
    v_perm_b32 v8, v21, v20, s84
    v_perm_b32 v9, v21, v20, s85
    v_perm_b32 v10, v23, v22, s84
    v_perm_b32 v11, v23, v22, s85
    ds_write_b128 v7, v[8:11] offset:4096
    v_perm_b32 v8, v25, v24, s84
    v_perm_b32 v9, v25, v24, s85
    v_perm_b32 v10, v27, v26, s84
    v_perm_b32 v11, v27, v26, s85
    ds_write_b128 v7, v[8:11] offset:8192
pm_done_6:
    s_nop 3
    s_waitcnt lgkmcnt(0)
    s_lshl_b32 s32, s24, 10
    buffer_load_dwordx4 v[10:13], v0, s[16:19], s32 offen
    v_mov_b32 v20, -1
    v_mov_b32 v21, -1
    v_mov_b32 v22, -1
    v_mov_b32 v23, -1
    s_lshl_b32 s32, s24, 10
    v_add_u32 v24, s32, v0
    s_mul_i32 s32, s21, 106496
    s_add_u32 s32, s32, 1048576
    buffer_store_dwordx4 v[20:23], v24, s[12:15], s32 offen sc1
    s_add_u32 s32, s32, 0x2000
    buffer_store_dwordx4 v[20:23], v24, s[12:15], s32 offen sc1
    s_add_u32 s32, s32, 0x2000
    buffer_store_dwordx4 v[20:23], v24, s[12:15], s32 offen sc1
    s_add_u32 s32, s32, 0x2000
    buffer_store_dwordx4 v[20:23], v24, s[12:15], s32 offen sc1
    s_add_u32 s32, s32, 0x2000
    buffer_store_dwordx4 v[20:23], v24, s[12:15], s32 offen sc1
    s_add_u32 s32, s32, 0x2000
    buffer_store_dwordx4 v[20:23], v24, s[12:15], s32 offen sc1
    s_add_u32 s32, s32, 0x2000
    buffer_store_dwordx4 v[20:23], v24, s[12:15], s32 offen sc1
    s_add_u32 s32, s32, 0x2000
    buffer_store_dwordx4 v[20:23], v24, s[12:15], s32 offen sc1
    s_add_u32 s32, s32, 0x2000
    buffer_store_dwordx4 v[20:23], v24, s[12:15], s32 offen sc1
    s_add_u32 s32, s32, 0x2000
    buffer_store_dwordx4 v[20:23], v24, s[12:15], s32 offen sc1
    s_add_u32 s32, s32, 0x2000
    buffer_store_dwordx4 v[20:23], v24, s[12:15], s32 offen sc1
    s_add_u32 s32, s32, 0x2000
    buffer_store_dwordx4 v[20:23], v24, s[12:15], s32 offen sc1
    s_add_u32 s32, s32, 0x2000
    buffer_store_dwordx4 v[20:23], v24, s[12:15], s32 offen sc1
    s_waitcnt vmcnt(13)
    v_lshlrev_b32 v2, 16, v10
    v_and_b32 v3, 0xffff0000, v10
    v_lshlrev_b32 v4, 16, v11
    v_and_b32 v5, 0xffff0000, v11
    v_lshlrev_b32 v6, 16, v12
    v_and_b32 v7, 0xffff0000, v12
    v_lshlrev_b32 v8, 16, v13
    v_and_b32 v9, 0xffff0000, v13
    v_add_f32 v14, v2, v3
    v_add_f32 v14, v14, v4
    v_add_f32 v14, v14, v5
    v_add_f32 v14, v14, v6
    v_add_f32 v14, v14, v7
    v_add_f32 v14, v14, v8
    v_add_f32 v14, v14, v9
    s_nop 1
    v_add_f32_dpp v14, v14, v14 row_ror:8 row_mask:0xf bank_mask:0xf
    s_nop 1
    v_add_f32_dpp v14, v14, v14 row_ror:4 row_mask:0xf bank_mask:0xf
    s_nop 1
    v_add_f32_dpp v14, v14, v14 row_ror:2 row_mask:0xf bank_mask:0xf
    s_nop 1
    v_add_f32_dpp v14, v14, v14 row_ror:1 row_mask:0xf bank_mask:0xf
    v_mov_b32 v15, v14
    s_nop 1
    v_permlane16_swap_b32 v14, v15
    v_add_f32 v14, v14, v15
    v_mov_b32 v15, v14
    s_nop 1
    v_permlane32_swap_b32 v14, v15
    v_add_f32 v14, v14, v15
    v_mul_f32 v14, 0x3b000000, v14
    v_sub_f32 v16, v2, v14
    v_mul_f32 v15, v16, v16
    v_sub_f32 v16, v3, v14
    v_fma_f32 v15, v16, v16, v15
    v_sub_f32 v16, v4, v14
    v_fma_f32 v15, v16, v16, v15
    v_sub_f32 v16, v5, v14
    v_fma_f32 v15, v16, v16, v15
    v_sub_f32 v16, v6, v14
    v_fma_f32 v15, v16, v16, v15
    v_sub_f32 v16, v7, v14
    v_fma_f32 v15, v16, v16, v15
    v_sub_f32 v16, v8, v14
    v_fma_f32 v15, v16, v16, v15
    v_sub_f32 v16, v9, v14
    v_fma_f32 v15, v16, v16, v15
    s_nop 1
    v_add_f32_dpp v15, v15, v15 row_ror:8 row_mask:0xf bank_mask:0xf
    s_nop 1
    v_add_f32_dpp v15, v15, v15 row_ror:4 row_mask:0xf bank_mask:0xf
    s_nop 1
    v_add_f32_dpp v15, v15, v15 row_ror:2 row_mask:0xf bank_mask:0xf
    s_nop 1
    v_add_f32_dpp v15, v15, v15 row_ror:1 row_mask:0xf bank_mask:0xf
    v_mov_b32 v16, v15
    s_nop 1
    v_permlane16_swap_b32 v15, v16
    v_add_f32 v15, v15, v16
    v_mov_b32 v16, v15
    s_nop 1
    v_permlane32_swap_b32 v15, v16
    v_add_f32 v15, v15, v16
    v_mul_f32 v15, 0x3b000000, v15
    v_cvt_pk_bf16_f32 v16, v14, v15
    v_lshlrev_b32 v14, 16, v16
    v_and_b32 v15, 0xffff0000, v16
    v_add_f32 v15, 0x3727c5ac, v15
    v_cvt_pk_bf16_f32 v16, v15, v15
    v_lshlrev_b32 v15, 16, v16
    v_sqrt_f32 v15, v15
    s_nop 0
    v_cvt_pk_bf16_f32 v16, v15, v15
    v_lshlrev_b32 v15, 16, v16
    v_rcp_f32 v15, v15
    v_sub_f32 v2, v2, v14
    v_sub_f32 v3, v3, v14
    v_cvt_pk_bf16_f32 v16, v2, v3
    v_lshlrev_b32 v2, 16, v16
    v_and_b32 v3, 0xffff0000, v16
    v_mul_f32 v2, v2, v15
    v_mul_f32 v3, v3, v15
    v_cvt_pk_bf16_f32 v10, v2, v3
    v_sub_f32 v4, v4, v14
    v_sub_f32 v5, v5, v14
    v_cvt_pk_bf16_f32 v16, v4, v5
    v_lshlrev_b32 v4, 16, v16
    v_and_b32 v5, 0xffff0000, v16
    v_mul_f32 v4, v4, v15
    v_mul_f32 v5, v5, v15
    v_cvt_pk_bf16_f32 v11, v4, v5
    v_sub_f32 v6, v6, v14
    v_sub_f32 v7, v7, v14
    v_cvt_pk_bf16_f32 v16, v6, v7
    v_lshlrev_b32 v6, 16, v16
    v_and_b32 v7, 0xffff0000, v16
    v_mul_f32 v6, v6, v15
    v_mul_f32 v7, v7, v15
    v_cvt_pk_bf16_f32 v12, v6, v7
    v_sub_f32 v8, v8, v14
    v_sub_f32 v9, v9, v14
    v_cvt_pk_bf16_f32 v16, v8, v9
    v_lshlrev_b32 v8, 16, v16
    v_and_b32 v9, 0xffff0000, v16
    v_mul_f32 v8, v8, v15
    v_mul_f32 v9, v9, v15
    v_cvt_pk_bf16_f32 v13, v8, v9
    s_lshl_b32 s32, s24, 10
    s_add_u32 s32, s32, 147456
    v_add_u32 v26, s32, v0
    ds_write_b128 v26, v[10:13]
    s_waitcnt lgkmcnt(0)
    s_barrier
    s_lshl_b32 s32, s24, 10
    s_add_u32 s32, s32, 90112
    v_add_u32 v26, s32, v0
    ds_read_b128 v[32:35], v26 offset:0
    ds_read_b128 v[36:39], v26 offset:8192
    ds_read_b128 v[40:43], v26 offset:16384
    ds_read_b128 v[44:47], v26 offset:24576
    v_add_u32 v26, 147456, v0
    v_mov_b32 v25, 0
    s_lshl_b32 s34, s21, 6
    s_lshl_b32 s33, s24, 3
    s_add_u32 s34, s34, s33
    ds_read_b128 v[10:13], v26 offset:0
    s_waitcnt lgkmcnt(0)
    v_dot2_f32_bf16 v2, v32, v10, 0
    v_dot2_f32_bf16 v3, v33, v10, 0
    v_dot2_f32_bf16 v4, v34, v10, 0
    v_dot2_f32_bf16 v5, v35, v10, 0
    v_dot2_f32_bf16 v2, v36, v11, v2
    v_dot2_f32_bf16 v3, v37, v11, v3
    v_dot2_f32_bf16 v4, v38, v11, v4
    v_dot2_f32_bf16 v5, v39, v11, v5
    v_dot2_f32_bf16 v2, v40, v12, v2
    v_dot2_f32_bf16 v3, v41, v12, v3
    v_dot2_f32_bf16 v4, v42, v12, v4
    v_dot2_f32_bf16 v5, v43, v12, v5
    v_dot2_f32_bf16 v2, v44, v13, v2
    v_dot2_f32_bf16 v3, v45, v13, v3
    v_dot2_f32_bf16 v4, v46, v13, v4
    v_dot2_f32_bf16 v5, v47, v13, v5
    s_nop 1
    v_permlane32_swap_b32 v2, v4
    v_permlane32_swap_b32 v3, v5
    v_add_f32 v2, v2, v4
    v_add_f32 v3, v3, v5
    s_nop 1
    v_permlane16_swap_b32 v2, v3
    v_add_f32 v2, v2, v3
    s_nop 1
    v_add_f32_dpp v2, v2, v2 row_ror:8 row_mask:0xf bank_mask:0xf
    s_nop 1
    v_add_f32_dpp v2, v2, v2 row_ror:4 row_mask:0xf bank_mask:0xf
    s_nop 1
    v_add_f32_dpp v2, v2, v2 row_ror:2 row_mask:0xf bank_mask:0xf
    s_nop 1
    v_add_f32_dpp v2, v2, v2 row_ror:1 row_mask:0xf bank_mask:0xf
    v_cvt_pk_bf16_f32 v6, v2, v2
    v_lshlrev_b32 v2, 16, v6
    s_nop 0
    v_readlane_b32 s40, v2, 0
    v_readlane_b32 s41, v2, 16
    v_readlane_b32 s42, v2, 32
    v_readlane_b32 s43, v2, 48
    s_pack_hh_b32_b16 s40, s40, s41
    s_pack_hh_b32_b16 s41, s42, s43
    v_mov_b32 v2, s40
    v_mov_b32 v3, s41
    s_add_u32 s32, s34, 0
    s_mov_b64 exec, 1
    buffer_store_dwordx2 v[2:3], v25, s[12:15], s32 offen sc1
    s_mov_b64 exec, -1
    ds_read_b128 v[10:13], v26 offset:1024
    s_waitcnt lgkmcnt(0)
    v_dot2_f32_bf16 v2, v32, v10, 0
    v_dot2_f32_bf16 v3, v33, v10, 0
    v_dot2_f32_bf16 v4, v34, v10, 0
    v_dot2_f32_bf16 v5, v35, v10, 0
    v_dot2_f32_bf16 v2, v36, v11, v2
    v_dot2_f32_bf16 v3, v37, v11, v3
    v_dot2_f32_bf16 v4, v38, v11, v4
    v_dot2_f32_bf16 v5, v39, v11, v5
    v_dot2_f32_bf16 v2, v40, v12, v2
    v_dot2_f32_bf16 v3, v41, v12, v3
    v_dot2_f32_bf16 v4, v42, v12, v4
    v_dot2_f32_bf16 v5, v43, v12, v5
    v_dot2_f32_bf16 v2, v44, v13, v2
    v_dot2_f32_bf16 v3, v45, v13, v3
    v_dot2_f32_bf16 v4, v46, v13, v4
    v_dot2_f32_bf16 v5, v47, v13, v5
    s_nop 1
    v_permlane32_swap_b32 v2, v4
    v_permlane32_swap_b32 v3, v5
    v_add_f32 v2, v2, v4
    v_add_f32 v3, v3, v5
    s_nop 1
    v_permlane16_swap_b32 v2, v3
    v_add_f32 v2, v2, v3
    s_nop 1
    v_add_f32_dpp v2, v2, v2 row_ror:8 row_mask:0xf bank_mask:0xf
    s_nop 1
    v_add_f32_dpp v2, v2, v2 row_ror:4 row_mask:0xf bank_mask:0xf
    s_nop 1
    v_add_f32_dpp v2, v2, v2 row_ror:2 row_mask:0xf bank_mask:0xf
    s_nop 1
    v_add_f32_dpp v2, v2, v2 row_ror:1 row_mask:0xf bank_mask:0xf
    v_cvt_pk_bf16_f32 v6, v2, v2
    v_lshlrev_b32 v2, 16, v6
    s_nop 0
    v_readlane_b32 s40, v2, 0
    v_readlane_b32 s41, v2, 16
    v_readlane_b32 s42, v2, 32
    v_readlane_b32 s43, v2, 48
    s_pack_hh_b32_b16 s40, s40, s41
    s_pack_hh_b32_b16 s41, s42, s43
    v_mov_b32 v2, s40
    v_mov_b32 v3, s41
    s_add_u32 s32, s34, 8192
    s_mov_b64 exec, 1
    buffer_store_dwordx2 v[2:3], v25, s[12:15], s32 offen sc1
    s_mov_b64 exec, -1
    ds_read_b128 v[10:13], v26 offset:2048
    s_waitcnt lgkmcnt(0)
    v_dot2_f32_bf16 v2, v32, v10, 0
    v_dot2_f32_bf16 v3, v33, v10, 0
    v_dot2_f32_bf16 v4, v34, v10, 0
    v_dot2_f32_bf16 v5, v35, v10, 0
    v_dot2_f32_bf16 v2, v36, v11, v2
    v_dot2_f32_bf16 v3, v37, v11, v3
    v_dot2_f32_bf16 v4, v38, v11, v4
    v_dot2_f32_bf16 v5, v39, v11, v5
    v_dot2_f32_bf16 v2, v40, v12, v2
    v_dot2_f32_bf16 v3, v41, v12, v3
    v_dot2_f32_bf16 v4, v42, v12, v4
    v_dot2_f32_bf16 v5, v43, v12, v5
    v_dot2_f32_bf16 v2, v44, v13, v2
    v_dot2_f32_bf16 v3, v45, v13, v3
    v_dot2_f32_bf16 v4, v46, v13, v4
    v_dot2_f32_bf16 v5, v47, v13, v5
    s_nop 1
    v_permlane32_swap_b32 v2, v4
    v_permlane32_swap_b32 v3, v5
    v_add_f32 v2, v2, v4
    v_add_f32 v3, v3, v5
    s_nop 1
    v_permlane16_swap_b32 v2, v3
    v_add_f32 v2, v2, v3
    s_nop 1
    v_add_f32_dpp v2, v2, v2 row_ror:8 row_mask:0xf bank_mask:0xf
    s_nop 1
    v_add_f32_dpp v2, v2, v2 row_ror:4 row_mask:0xf bank_mask:0xf
    s_nop 1
    v_add_f32_dpp v2, v2, v2 row_ror:2 row_mask:0xf bank_mask:0xf
    s_nop 1
    v_add_f32_dpp v2, v2, v2 row_ror:1 row_mask:0xf bank_mask:0xf
    v_cvt_pk_bf16_f32 v6, v2, v2
    v_lshlrev_b32 v2, 16, v6
    s_nop 0
    v_readlane_b32 s40, v2, 0
    v_readlane_b32 s41, v2, 16
    v_readlane_b32 s42, v2, 32
    v_readlane_b32 s43, v2, 48
    s_pack_hh_b32_b16 s40, s40, s41
    s_pack_hh_b32_b16 s41, s42, s43
    v_mov_b32 v2, s40
    v_mov_b32 v3, s41
    s_add_u32 s32, s34, 16384
    s_mov_b64 exec, 1
    buffer_store_dwordx2 v[2:3], v25, s[12:15], s32 offen sc1
    s_mov_b64 exec, -1
    ds_read_b128 v[10:13], v26 offset:3072
    s_waitcnt lgkmcnt(0)
    v_dot2_f32_bf16 v2, v32, v10, 0
    v_dot2_f32_bf16 v3, v33, v10, 0
    v_dot2_f32_bf16 v4, v34, v10, 0
    v_dot2_f32_bf16 v5, v35, v10, 0
    v_dot2_f32_bf16 v2, v36, v11, v2
    v_dot2_f32_bf16 v3, v37, v11, v3
    v_dot2_f32_bf16 v4, v38, v11, v4
    v_dot2_f32_bf16 v5, v39, v11, v5
    v_dot2_f32_bf16 v2, v40, v12, v2
    v_dot2_f32_bf16 v3, v41, v12, v3
    v_dot2_f32_bf16 v4, v42, v12, v4
    v_dot2_f32_bf16 v5, v43, v12, v5
    v_dot2_f32_bf16 v2, v44, v13, v2
    v_dot2_f32_bf16 v3, v45, v13, v3
    v_dot2_f32_bf16 v4, v46, v13, v4
    v_dot2_f32_bf16 v5, v47, v13, v5
    s_nop 1
    v_permlane32_swap_b32 v2, v4
    v_permlane32_swap_b32 v3, v5
    v_add_f32 v2, v2, v4
    v_add_f32 v3, v3, v5
    s_nop 1
    v_permlane16_swap_b32 v2, v3
    v_add_f32 v2, v2, v3
    s_nop 1
    v_add_f32_dpp v2, v2, v2 row_ror:8 row_mask:0xf bank_mask:0xf
    s_nop 1
    v_add_f32_dpp v2, v2, v2 row_ror:4 row_mask:0xf bank_mask:0xf
    s_nop 1
    v_add_f32_dpp v2, v2, v2 row_ror:2 row_mask:0xf bank_mask:0xf
    s_nop 1
    v_add_f32_dpp v2, v2, v2 row_ror:1 row_mask:0xf bank_mask:0xf
    v_cvt_pk_bf16_f32 v6, v2, v2
    v_lshlrev_b32 v2, 16, v6
    s_nop 0
    v_readlane_b32 s40, v2, 0
    v_readlane_b32 s41, v2, 16
    v_readlane_b32 s42, v2, 32
    v_readlane_b32 s43, v2, 48
    s_pack_hh_b32_b16 s40, s40, s41
    s_pack_hh_b32_b16 s41, s42, s43
    v_mov_b32 v2, s40
    v_mov_b32 v3, s41
    s_add_u32 s32, s34, 24576
    s_mov_b64 exec, 1
    buffer_store_dwordx2 v[2:3], v25, s[12:15], s32 offen sc1
    s_mov_b64 exec, -1
    ds_read_b128 v[10:13], v26 offset:4096
    s_waitcnt lgkmcnt(0)
    v_dot2_f32_bf16 v2, v32, v10, 0
    v_dot2_f32_bf16 v3, v33, v10, 0
    v_dot2_f32_bf16 v4, v34, v10, 0
    v_dot2_f32_bf16 v5, v35, v10, 0
    v_dot2_f32_bf16 v2, v36, v11, v2
    v_dot2_f32_bf16 v3, v37, v11, v3
    v_dot2_f32_bf16 v4, v38, v11, v4
    v_dot2_f32_bf16 v5, v39, v11, v5
    v_dot2_f32_bf16 v2, v40, v12, v2
    v_dot2_f32_bf16 v3, v41, v12, v3
    v_dot2_f32_bf16 v4, v42, v12, v4
    v_dot2_f32_bf16 v5, v43, v12, v5
    v_dot2_f32_bf16 v2, v44, v13, v2
    v_dot2_f32_bf16 v3, v45, v13, v3
    v_dot2_f32_bf16 v4, v46, v13, v4
    v_dot2_f32_bf16 v5, v47, v13, v5
    s_nop 1
    v_permlane32_swap_b32 v2, v4
    v_permlane32_swap_b32 v3, v5
    v_add_f32 v2, v2, v4
    v_add_f32 v3, v3, v5
    s_nop 1
    v_permlane16_swap_b32 v2, v3
    v_add_f32 v2, v2, v3
    s_nop 1
    v_add_f32_dpp v2, v2, v2 row_ror:8 row_mask:0xf bank_mask:0xf
    s_nop 1
    v_add_f32_dpp v2, v2, v2 row_ror:4 row_mask:0xf bank_mask:0xf
    s_nop 1
    v_add_f32_dpp v2, v2, v2 row_ror:2 row_mask:0xf bank_mask:0xf
    s_nop 1
    v_add_f32_dpp v2, v2, v2 row_ror:1 row_mask:0xf bank_mask:0xf
    v_cvt_pk_bf16_f32 v6, v2, v2
    v_lshlrev_b32 v2, 16, v6
    s_nop 0
    v_readlane_b32 s40, v2, 0
    v_readlane_b32 s41, v2, 16
    v_readlane_b32 s42, v2, 32
    v_readlane_b32 s43, v2, 48
    s_pack_hh_b32_b16 s40, s40, s41
    s_pack_hh_b32_b16 s41, s42, s43
    v_mov_b32 v2, s40
    v_mov_b32 v3, s41
    s_add_u32 s32, s34, 32768
    s_mov_b64 exec, 1
    buffer_store_dwordx2 v[2:3], v25, s[12:15], s32 offen sc1
    s_mov_b64 exec, -1
    ds_read_b128 v[10:13], v26 offset:5120
    s_waitcnt lgkmcnt(0)
    v_dot2_f32_bf16 v2, v32, v10, 0
    v_dot2_f32_bf16 v3, v33, v10, 0
    v_dot2_f32_bf16 v4, v34, v10, 0
    v_dot2_f32_bf16 v5, v35, v10, 0
    v_dot2_f32_bf16 v2, v36, v11, v2
    v_dot2_f32_bf16 v3, v37, v11, v3
    v_dot2_f32_bf16 v4, v38, v11, v4
    v_dot2_f32_bf16 v5, v39, v11, v5
    v_dot2_f32_bf16 v2, v40, v12, v2
    v_dot2_f32_bf16 v3, v41, v12, v3
    v_dot2_f32_bf16 v4, v42, v12, v4
    v_dot2_f32_bf16 v5, v43, v12, v5
    v_dot2_f32_bf16 v2, v44, v13, v2
    v_dot2_f32_bf16 v3, v45, v13, v3
    v_dot2_f32_bf16 v4, v46, v13, v4
    v_dot2_f32_bf16 v5, v47, v13, v5
    s_nop 1
    v_permlane32_swap_b32 v2, v4
    v_permlane32_swap_b32 v3, v5
    v_add_f32 v2, v2, v4
    v_add_f32 v3, v3, v5
    s_nop 1
    v_permlane16_swap_b32 v2, v3
    v_add_f32 v2, v2, v3
    s_nop 1
    v_add_f32_dpp v2, v2, v2 row_ror:8 row_mask:0xf bank_mask:0xf
    s_nop 1
    v_add_f32_dpp v2, v2, v2 row_ror:4 row_mask:0xf bank_mask:0xf
    s_nop 1
    v_add_f32_dpp v2, v2, v2 row_ror:2 row_mask:0xf bank_mask:0xf
    s_nop 1
    v_add_f32_dpp v2, v2, v2 row_ror:1 row_mask:0xf bank_mask:0xf
    v_cvt_pk_bf16_f32 v6, v2, v2
    v_lshlrev_b32 v2, 16, v6
    s_nop 0
    v_readlane_b32 s40, v2, 0
    v_readlane_b32 s41, v2, 16
    v_readlane_b32 s42, v2, 32
    v_readlane_b32 s43, v2, 48
    s_pack_hh_b32_b16 s40, s40, s41
    s_pack_hh_b32_b16 s41, s42, s43
    v_mov_b32 v2, s40
    v_mov_b32 v3, s41
    s_add_u32 s32, s34, 40960
    s_mov_b64 exec, 1
    buffer_store_dwordx2 v[2:3], v25, s[12:15], s32 offen sc1
    s_mov_b64 exec, -1
    ds_read_b128 v[10:13], v26 offset:6144
    s_waitcnt lgkmcnt(0)
    v_dot2_f32_bf16 v2, v32, v10, 0
    v_dot2_f32_bf16 v3, v33, v10, 0
    v_dot2_f32_bf16 v4, v34, v10, 0
    v_dot2_f32_bf16 v5, v35, v10, 0
    v_dot2_f32_bf16 v2, v36, v11, v2
    v_dot2_f32_bf16 v3, v37, v11, v3
    v_dot2_f32_bf16 v4, v38, v11, v4
    v_dot2_f32_bf16 v5, v39, v11, v5
    v_dot2_f32_bf16 v2, v40, v12, v2
    v_dot2_f32_bf16 v3, v41, v12, v3
    v_dot2_f32_bf16 v4, v42, v12, v4
    v_dot2_f32_bf16 v5, v43, v12, v5
    v_dot2_f32_bf16 v2, v44, v13, v2
    v_dot2_f32_bf16 v3, v45, v13, v3
    v_dot2_f32_bf16 v4, v46, v13, v4
    v_dot2_f32_bf16 v5, v47, v13, v5
    s_nop 1
    v_permlane32_swap_b32 v2, v4
    v_permlane32_swap_b32 v3, v5
    v_add_f32 v2, v2, v4
    v_add_f32 v3, v3, v5
    s_nop 1
    v_permlane16_swap_b32 v2, v3
    v_add_f32 v2, v2, v3
    s_nop 1
    v_add_f32_dpp v2, v2, v2 row_ror:8 row_mask:0xf bank_mask:0xf
    s_nop 1
    v_add_f32_dpp v2, v2, v2 row_ror:4 row_mask:0xf bank_mask:0xf
    s_nop 1
    v_add_f32_dpp v2, v2, v2 row_ror:2 row_mask:0xf bank_mask:0xf
    s_nop 1
    v_add_f32_dpp v2, v2, v2 row_ror:1 row_mask:0xf bank_mask:0xf
    v_cvt_pk_bf16_f32 v6, v2, v2
    v_lshlrev_b32 v2, 16, v6
    s_nop 0
    v_readlane_b32 s40, v2, 0
    v_readlane_b32 s41, v2, 16
    v_readlane_b32 s42, v2, 32
    v_readlane_b32 s43, v2, 48
    s_pack_hh_b32_b16 s40, s40, s41
    s_pack_hh_b32_b16 s41, s42, s43
    v_mov_b32 v2, s40
    v_mov_b32 v3, s41
    s_add_u32 s32, s34, 49152
    s_mov_b64 exec, 1
    buffer_store_dwordx2 v[2:3], v25, s[12:15], s32 offen sc1
    s_mov_b64 exec, -1
    ds_read_b128 v[10:13], v26 offset:7168
    s_waitcnt lgkmcnt(0)
    v_dot2_f32_bf16 v2, v32, v10, 0
    v_dot2_f32_bf16 v3, v33, v10, 0
    v_dot2_f32_bf16 v4, v34, v10, 0
    v_dot2_f32_bf16 v5, v35, v10, 0
    v_dot2_f32_bf16 v2, v36, v11, v2
    v_dot2_f32_bf16 v3, v37, v11, v3
    v_dot2_f32_bf16 v4, v38, v11, v4
    v_dot2_f32_bf16 v5, v39, v11, v5
    v_dot2_f32_bf16 v2, v40, v12, v2
    v_dot2_f32_bf16 v3, v41, v12, v3
    v_dot2_f32_bf16 v4, v42, v12, v4
    v_dot2_f32_bf16 v5, v43, v12, v5
    v_dot2_f32_bf16 v2, v44, v13, v2
    v_dot2_f32_bf16 v3, v45, v13, v3
    v_dot2_f32_bf16 v4, v46, v13, v4
    v_dot2_f32_bf16 v5, v47, v13, v5
    s_nop 1
    v_permlane32_swap_b32 v2, v4
    v_permlane32_swap_b32 v3, v5
    v_add_f32 v2, v2, v4
    v_add_f32 v3, v3, v5
    s_nop 1
    v_permlane16_swap_b32 v2, v3
    v_add_f32 v2, v2, v3
    s_nop 1
    v_add_f32_dpp v2, v2, v2 row_ror:8 row_mask:0xf bank_mask:0xf
    s_nop 1
    v_add_f32_dpp v2, v2, v2 row_ror:4 row_mask:0xf bank_mask:0xf
    s_nop 1
    v_add_f32_dpp v2, v2, v2 row_ror:2 row_mask:0xf bank_mask:0xf
    s_nop 1
    v_add_f32_dpp v2, v2, v2 row_ror:1 row_mask:0xf bank_mask:0xf
    v_cvt_pk_bf16_f32 v6, v2, v2
    v_lshlrev_b32 v2, 16, v6
    s_nop 0
    v_readlane_b32 s40, v2, 0
    v_readlane_b32 s41, v2, 16
    v_readlane_b32 s42, v2, 32
    v_readlane_b32 s43, v2, 48
    s_pack_hh_b32_b16 s40, s40, s41
    s_pack_hh_b32_b16 s41, s42, s43
    v_mov_b32 v2, s40
    v_mov_b32 v3, s41
    s_add_u32 s32, s34, 57344
    s_mov_b64 exec, 1
    buffer_store_dwordx2 v[2:3], v25, s[12:15], s32 offen sc1
    s_mov_b64 exec, -1
    s_waitcnt vmcnt(0)
    s_barrier
    s_cmp_lg_u32 s24, 0
    s_cbranch_scc1 noatom_8
    v_mov_b32 v2, 1
    s_mov_b64 exec, 1
    buffer_atomic_add v2, v25, s[92:95], 0 offen sc1
    s_mov_b64 exec, -1
noatom_8:
    s_nop 3
    v_mov_b32 v9, 0
wc_9:
    s_nop 3
    buffer_load_dword v8, v9, s[92:95], 0 offen sc1
    s_waitcnt vmcnt(0)
    v_cmp_gt_u32 vcc, s98, v8
    s_cbranch_vccz wcd_10
    s_sleep 2
    s_sub_u32 s31, s31, 1
    s_cbranch_scc0 wc_9
    s_branch main_bail
wcd_10:
    s_nop 3
    v_and_b32 v6, 0xf0, v0
    v_lshrrev_b32 v7, 8, v0
    v_lshl_add_u32 v7, v7, 14, v6
    s_lshl_b32 s38, s20, 13
    s_lshl_b32 s34, s22, 8
    s_add_u32 s38, s38, s34
    buffer_load_dwordx4 v[8:11], v7, s[12:15], s38 offen offset:0 sc1
    v_add_u32 v7, 161280, v0
    s_waitcnt vmcnt(0)
    ds_write_b128 v7, v[8:11]
    s_waitcnt lgkmcnt(0)
    s_mul_i32 s32, s21, 576
    s_add_u32 s32, s32, 1048576
    v_mov_b32 v4, 0
poll_11:
    s_nop 3
    buffer_load_dword v2, v4, s[12:15], s32 offen offset:512 sc1
    s_waitcnt vmcnt(0)
    v_cmp_eq_u32 vcc, -1, v2
    s_cbranch_vccz polld_12
    s_sleep 1
    s_sub_u32 s31, s31, 1
    s_cbranch_scc0 poll_11
    s_branch main_bail
polld_12:
    s_nop 3
g0skip_4:
    s_nop 3
step_loop:
    s_nop 3
    s_mul_i32 s32, s20, 5
    s_add_u32 s32, s32, s27
    s_mul_i32 s29, s32, 1310720
    s_add_u32 s29, s29, 1048576
    s_mul_i32 s33, s26, 655360
    s_add_u32 s28, s29, s33
    s_add_u32 s53, s29, 1966080
    s_cmp_eq_u32 s27, 4
    s_cbranch_scc1 noatt1_13
    s_cmp_lg_u32 s27, 0
    s_cbranch_scc1 notstep0_14
    s_lshl_b32 s30, s20, 25
    s_add_u32 s30, s30, s39
    s_add_u32 s34, s30, 0
    buffer_load_dwordx4 v[28:31], v0, s[4:7], s34 offen offset:0 nt
    buffer_load_dwordx4 v[32:35], v0, s[4:7], s34 offen offset:1024 nt
    buffer_load_dwordx4 v[36:39], v0, s[4:7], s34 offen offset:2048 nt
    buffer_load_dwordx4 v[40:43], v0, s[4:7], s34 offen offset:3072 nt
    s_add_u32 s34, s30, 4096
    buffer_load_dwordx4 v[44:47], v0, s[4:7], s34 offen offset:0 nt
    buffer_load_dwordx4 v[48:51], v0, s[4:7], s34 offen offset:1024 nt
    buffer_load_dwordx4 v[52:55], v0, s[4:7], s34 offen offset:2048 nt
    buffer_load_dwordx4 v[56:59], v0, s[4:7], s34 offen offset:3072 nt
    s_add_u32 s34, s30, 0
    buffer_load_dwordx4 v[156:159], v0, s[8:11], s34 offen offset:0 nt
    buffer_load_dwordx4 v[160:163], v0, s[8:11], s34 offen offset:1024 nt
    buffer_load_dwordx4 v[164:167], v0, s[8:11], s34 offen offset:2048 nt
    buffer_load_dwordx4 v[168:171], v0, s[8:11], s34 offen offset:3072 nt
    s_add_u32 s34, s30, 4096
    buffer_load_dwordx4 v[172:175], v0, s[8:11], s34 offen offset:0 nt
    buffer_load_dwordx4 v[176:179], v0, s[8:11], s34 offen offset:1024 nt
    buffer_load_dwordx4 v[180:183], v0, s[8:11], s34 offen offset:2048 nt
    buffer_load_dwordx4 v[184:187], v0, s[8:11], s34 offen offset:3072 nt
    s_add_u32 s34, s30, 8192
    buffer_load_dwordx4 v[60:63], v0, s[4:7], s34 offen offset:0 nt
    buffer_load_dwordx4 v[64:67], v0, s[4:7], s34 offen offset:1024 nt
    buffer_load_dwordx4 v[68:71], v0, s[4:7], s34 offen offset:2048 nt
    buffer_load_dwordx4 v[72:75], v0, s[4:7], s34 offen offset:3072 nt
    s_add_u32 s34, s30, 12288
    buffer_load_dwordx4 v[76:79], v0, s[4:7], s34 offen offset:0 nt
    buffer_load_dwordx4 v[80:83], v0, s[4:7], s34 offen offset:1024 nt
    buffer_load_dwordx4 v[84:87], v0, s[4:7], s34 offen offset:2048 nt
    buffer_load_dwordx4 v[88:91], v0, s[4:7], s34 offen offset:3072 nt
    s_add_u32 s34, s30, 8192
    buffer_load_dwordx4 v[188:191], v0, s[8:11], s34 offen offset:0 nt
    buffer_load_dwordx4 v[192:195], v0, s[8:11], s34 offen offset:1024 nt
    buffer_load_dwordx4 v[196:199], v0, s[8:11], s34 offen offset:2048 nt
    buffer_load_dwordx4 v[200:203], v0, s[8:11], s34 offen offset:3072 nt
    s_add_u32 s34, s30, 12288
    buffer_load_dwordx4 v[204:207], v0, s[8:11], s34 offen offset:0 nt
    buffer_load_dwordx4 v[208:211], v0, s[8:11], s34 offen offset:1024 nt
    buffer_load_dwordx4 v[212:215], v0, s[8:11], s34 offen offset:2048 nt
    buffer_load_dwordx4 v[216:219], v0, s[8:11], s34 offen offset:3072 nt
    s_add_u32 s34, s30, 16384
    buffer_load_dwordx4 v[92:95], v0, s[4:7], s34 offen offset:0 nt
    buffer_load_dwordx4 v[96:99], v0, s[4:7], s34 offen offset:1024 nt
    buffer_load_dwordx4 v[100:103], v0, s[4:7], s34 offen offset:2048 nt
    buffer_load_dwordx4 v[104:107], v0, s[4:7], s34 offen offset:3072 nt
    s_add_u32 s34, s30, 20480
    buffer_load_dwordx4 v[108:111], v0, s[4:7], s34 offen offset:0 nt
    buffer_load_dwordx4 v[112:115], v0, s[4:7], s34 offen offset:1024 nt
    buffer_load_dwordx4 v[116:119], v0, s[4:7], s34 offen offset:2048 nt
    buffer_load_dwordx4 v[120:123], v0, s[4:7], s34 offen offset:3072 nt
    s_add_u32 s34, s30, 16384
    buffer_load_dwordx4 v[220:223], v0, s[8:11], s34 offen offset:0 nt
    buffer_load_dwordx4 v[224:227], v0, s[8:11], s34 offen offset:1024 nt
    buffer_load_dwordx4 v[228:231], v0, s[8:11], s34 offen offset:2048 nt
    buffer_load_dwordx4 v[232:235], v0, s[8:11], s34 offen offset:3072 nt
    s_add_u32 s34, s30, 20480
    buffer_load_dwordx4 v[236:239], v0, s[8:11], s34 offen offset:0 nt
    buffer_load_dwordx4 v[240:243], v0, s[8:11], s34 offen offset:1024 nt
    buffer_load_dwordx4 v[244:247], v0, s[8:11], s34 offen offset:2048 nt
    buffer_load_dwordx4 v[248:251], v0, s[8:11], s34 offen offset:3072 nt
    s_cmp_lg_u32 s20, 0
    s_cbranch_scc1 nostage_16
    s_waitcnt vmcnt(48)
    v_lshrrev_b32 v7, 6, v0
    v_and_b32 v8, 3, v7
    v_lshrrev_b32 v7, 2, v7
    v_lshlrev_b32 v7, 4, v7
    v_lshl_add_u32 v7, v8, 13, v7
    v_bfe_u32 v8, v0, 4, 2
    v_lshl_add_u32 v7, v8, 10, v7
    s_lshl_b32 s32, s24, 7
    s_add_u32 s32, s32, 57344
    v_add_u32 v7, s32, v7
    v_perm_b32 v8, v128, v124, s84
    v_perm_b32 v9, v128, v124, s85
    v_perm_b32 v10, v129, v125, s84
    v_perm_b32 v11, v129, v125, s85
    ds_write_b128 v7, v[8:11] offset:0
    v_perm_b32 v8, v130, v126, s84
    v_perm_b32 v9, v130, v126, s85
    v_perm_b32 v10, v131, v127, s84
    v_perm_b32 v11, v131, v127, s85
    ds_write_b128 v7, v[8:11] offset:4096
    v_perm_b32 v8, v136, v132, s84
    v_perm_b32 v9, v136, v132, s85
    v_perm_b32 v10, v137, v133, s84
    v_perm_b32 v11, v137, v133, s85
    ds_write_b128 v7, v[8:11] offset:64
    v_perm_b32 v8, v138, v134, s84
    v_perm_b32 v9, v138, v134, s85
    v_perm_b32 v10, v139, v135, s84
    v_perm_b32 v11, v139, v135, s85
    ds_write_b128 v7, v[8:11] offset:4160
    v_lshrrev_b32 v7, 6, v0
    v_and_b32 v8, 3, v7
    v_lshrrev_b32 v7, 2, v7
    v_lshlrev_b32 v7, 4, v7
    v_lshl_add_u32 v7, v8, 13, v7
    v_bfe_u32 v8, v0, 4, 2
    v_lshl_add_u32 v7, v8, 11, v7
    s_lshl_b32 s32, s24, 7
    s_add_u32 s32, s32, 90112
    v_add_u32 v7, s32, v7
    v_perm_b32 v8, v144, v140, s84
    v_perm_b32 v9, v144, v140, s85
    v_perm_b32 v10, v145, v141, s84
    v_perm_b32 v11, v145, v141, s85
    ds_write_b128 v7, v[8:11] offset:0
    v_perm_b32 v8, v146, v142, s84
    v_perm_b32 v9, v146, v142, s85
    v_perm_b32 v10, v147, v143, s84
    v_perm_b32 v11, v147, v143, s85
    ds_write_b128 v7, v[8:11] offset:1024
    v_perm_b32 v8, v152, v148, s84
    v_perm_b32 v9, v152, v148, s85
    v_perm_b32 v10, v153, v149, s84
    v_perm_b32 v11, v153, v149, s85
    ds_write_b128 v7, v[8:11] offset:64
    v_perm_b32 v8, v154, v150, s84
    v_perm_b32 v9, v154, v150, s85
    v_perm_b32 v10, v155, v151, s84
    v_perm_b32 v11, v155, v151, s85
    ds_write_b128 v7, v[8:11] offset:1088
    s_cmp_eq_u32 s26, 1
    s_cbranch_scc1 pm_w2_17
    s_cmp_lg_u32 s21, 114
    s_cbranch_scc1 nomask_19
    v_mov_b32 v20, 0
    v_mov_b32 v21, 0
    v_mov_b32 v26, 0
    v_mov_b32 v27, 0
nomask_19:
    s_nop 3
    s_mul_i32 s32, s25, 3072
    s_add_u32 s32, s32, 122880
    v_add_u32 v7, s32, v0
    v_perm_b32 v8, v22, v16, s84
    v_perm_b32 v9, v22, v16, s85
    v_perm_b32 v10, v23, v17, s84
    v_perm_b32 v11, v23, v17, s85
    ds_write_b128 v7, v[8:11] offset:0
    v_perm_b32 v8, v24, v18, s84
    v_perm_b32 v9, v24, v18, s85
    v_perm_b32 v10, v25, v19, s84
    v_perm_b32 v11, v25, v19, s85
    ds_write_b128 v7, v[8:11] offset:1024
    v_perm_b32 v8, v26, v20, s84
    v_perm_b32 v9, v26, v20, s85
    v_perm_b32 v10, v27, v21, s84
    v_perm_b32 v11, v27, v21, s85
    ds_write_b128 v7, v[8:11] offset:2048
    s_branch pm_done_18
pm_w2_17:
    s_nop 3
    s_lshl_b32 s32, s25, 10
    s_add_u32 s32, s32, 135168
    v_add_u32 v7, s32, v0
    v_perm_b32 v8, v17, v16, s84
    v_perm_b32 v9, v17, v16, s85
    v_perm_b32 v10, v19, v18, s84
    v_perm_b32 v11, v19, v18, s85
    ds_write_b128 v7, v[8:11] offset:0
    v_perm_b32 v8, v21, v20, s84
    v_perm_b32 v9, v21, v20, s85
    v_perm_b32 v10, v23, v22, s84
    v_perm_b32 v11, v23, v22, s85
    ds_write_b128 v7, v[8:11] offset:4096
    v_perm_b32 v8, v25, v24, s84
    v_perm_b32 v9, v25, v24, s85
    v_perm_b32 v10, v27, v26, s84
    v_perm_b32 v11, v27, v26, s85
    ds_write_b128 v7, v[8:11] offset:8192
pm_done_18:
    s_nop 3
    s_waitcnt lgkmcnt(0)
nostage_16:
    s_nop 3
    s_add_u32 s34, s30, 24576
    buffer_load_dwordx4 v[124:127], v0, s[4:7], s34 offen offset:0 nt
    buffer_load_dwordx4 v[128:131], v0, s[4:7], s34 offen offset:1024 nt
    buffer_load_dwordx4 v[132:135], v0, s[4:7], s34 offen offset:2048 nt
    buffer_load_dwordx4 v[136:139], v0, s[4:7], s34 offen offset:3072 nt
    s_add_u32 s34, s30, 28672
    buffer_load_dwordx4 v[140:143], v0, s[4:7], s34 offen offset:0 nt
    buffer_load_dwordx4 v[144:147], v0, s[4:7], s34 offen offset:1024 nt
    buffer_load_dwordx4 v[148:151], v0, s[4:7], s34 offen offset:2048 nt
    buffer_load_dwordx4 v[152:155], v0, s[4:7], s34 offen offset:3072 nt
    s_add_u32 s34, s30, 24576
    buffer_load_dwordx4 v[252:255], v0, s[8:11], s34 offen offset:0 nt
    s_add_u32 s35, s52, 0
    s_mov_b32 m0, s35
    s_add_u32 s35, s30, 25600
    buffer_load_dwordx4 v0, s[8:11], s35 offen nt lds
    s_add_u32 s35, s52, 1024
    s_mov_b32 m0, s35
    s_add_u32 s35, s30, 26624
    buffer_load_dwordx4 v0, s[8:11], s35 offen nt lds
    s_add_u32 s35, s52, 2048
    s_mov_b32 m0, s35
    s_add_u32 s35, s30, 27648
    buffer_load_dwordx4 v0, s[8:11], s35 offen nt lds
    s_add_u32 s34, s30, 28672
    s_add_u32 s35, s52, 3072
    s_mov_b32 m0, s35
    s_add_u32 s35, s30, 28672
    buffer_load_dwordx4 v0, s[8:11], s35 offen nt lds
    s_add_u32 s35, s52, 4096
    s_mov_b32 m0, s35
    s_add_u32 s35, s30, 29696
    buffer_load_dwordx4 v0, s[8:11], s35 offen nt lds
    s_add_u32 s35, s52, 5120
    s_mov_b32 m0, s35
    s_add_u32 s35, s30, 30720
    buffer_load_dwordx4 v0, s[8:11], s35 offen nt lds
    s_add_u32 s35, s52, 6144
    s_mov_b32 m0, s35
    s_add_u32 s35, s30, 31744
    buffer_load_dwordx4 v0, s[8:11], s35 offen nt lds
    s_cmp_lg_u32 s20, 0
    s_cbranch_scc1 qdone_15
    v_mov_b32 v9, 0
wc_20:
    s_nop 3
    buffer_load_dword v8, v9, s[92:95], 0 offen sc1
    s_waitcnt vmcnt(0)
    v_cmp_gt_u32 vcc, s98, v8
    s_cbranch_vccz wcd_21
    s_sleep 2
    s_sub_u32 s31, s31, 1
    s_cbranch_scc0 wc_20
    s_branch main_bail
wcd_21:
    s_nop 3
    v_and_b32 v6, 0xf0, v0
    v_lshrrev_b32 v7, 8, v0
    v_lshl_add_u32 v7, v7, 14, v6
    s_lshl_b32 s38, s20, 13
    s_lshl_b32 s34, s22, 8
    s_add_u32 s38, s38, s34
    buffer_load_dwordx4 v[8:11], v7, s[12:15], s38 offen offset:0 sc1
    v_add_u32 v7, 161280, v0
    s_waitcnt vmcnt(0)
    ds_write_b128 v7, v[8:11]
    s_waitcnt lgkmcnt(0)
    s_branch qdone_15
notstep0_14:
    s_nop 3
    s_add_u32 s34, s30, 24576
    buffer_load_dwordx4 v[124:127], v0, s[4:7], s34 offen offset:0 nt
    buffer_load_dwordx4 v[128:131], v0, s[4:7], s34 offen offset:1024 nt
    buffer_load_dwordx4 v[132:135], v0, s[4:7], s34 offen offset:2048 nt
    buffer_load_dwordx4 v[136:139], v0, s[4:7], s34 offen offset:3072 nt
    s_add_u32 s34, s30, 28672
    buffer_load_dwordx4 v[140:143], v0, s[4:7], s34 offen offset:0 nt
    buffer_load_dwordx4 v[144:147], v0, s[4:7], s34 offen offset:1024 nt
    buffer_load_dwordx4 v[148:151], v0, s[4:7], s34 offen offset:2048 nt
    buffer_load_dwordx4 v[152:155], v0, s[4:7], s34 offen offset:3072 nt
    s_add_u32 s34, s30, 24576
    buffer_load_dwordx4 v[252:255], v0, s[8:11], s34 offen offset:0 nt
    s_add_u32 s35, s52, 0
    s_mov_b32 m0, s35
    s_add_u32 s35, s30, 25600
    buffer_load_dwordx4 v0, s[8:11], s35 offen nt lds
    s_add_u32 s35, s52, 1024
    s_mov_b32 m0, s35
    s_add_u32 s35, s30, 26624
    buffer_load_dwordx4 v0, s[8:11], s35 offen nt lds
    s_add_u32 s35, s52, 2048
    s_mov_b32 m0, s35
    s_add_u32 s35, s30, 27648
    buffer_load_dwordx4 v0, s[8:11], s35 offen nt lds
    s_add_u32 s34, s30, 28672
    s_add_u32 s35, s52, 3072
    s_mov_b32 m0, s35
    s_add_u32 s35, s30, 28672
    buffer_load_dwordx4 v0, s[8:11], s35 offen nt lds
    s_add_u32 s35, s52, 4096
    s_mov_b32 m0, s35
    s_add_u32 s35, s30, 29696
    buffer_load_dwordx4 v0, s[8:11], s35 offen nt lds
    s_add_u32 s35, s52, 5120
    s_mov_b32 m0, s35
    s_add_u32 s35, s30, 30720
    buffer_load_dwordx4 v0, s[8:11], s35 offen nt lds
    s_add_u32 s35, s52, 6144
    s_mov_b32 m0, s35
    s_add_u32 s35, s30, 31744
    buffer_load_dwordx4 v0, s[8:11], s35 offen nt lds
qdone_15:
    s_nop 3
    s_lshl_b32 s32, s27, 8
    s_add_u32 s32, s32, 161280
    v_and_b32 v6, 0xf0, v0
    v_add_u32 v6, s32, v6
    ds_read_b128 v[2:5], v6
    s_waitcnt lgkmcnt(0)
    v_mov_b32 v6, 0
    v_mov_b32 v7, 0
    v_mov_b32 v8, 0
    v_mov_b32 v9, 0
    v_mov_b32 v10, 0
    v_mov_b32 v11, 0
    v_mov_b32 v12, 0
    v_mov_b32 v13, 0
    v_mov_b32 v14, 0xff7fffff
    v_mov_b32 v15, 0
    s_waitcnt vmcnt(56)
    v_dot2_f32_bf16 v16, v28, v2, 0
    v_dot2_f32_bf16 v17, v32, v2, 0
    v_dot2_f32_bf16 v18, v36, v2, 0
    v_dot2_f32_bf16 v19, v40, v2, 0
    v_dot2_f32_bf16 v20, v44, v2, 0
    v_dot2_f32_bf16 v21, v48, v2, 0
    v_dot2_f32_bf16 v22, v52, v2, 0
    v_dot2_f32_bf16 v23, v56, v2, 0
    v_dot2_f32_bf16 v16, v29, v3, v16
    v_dot2_f32_bf16 v17, v33, v3, v17
    v_dot2_f32_bf16 v18, v37, v3, v18
    v_dot2_f32_bf16 v19, v41, v3, v19
    v_dot2_f32_bf16 v20, v45, v3, v20
    v_dot2_f32_bf16 v21, v49, v3, v21
    v_dot2_f32_bf16 v22, v53, v3, v22
    v_dot2_f32_bf16 v23, v57, v3, v23
    v_dot2_f32_bf16 v16, v30, v4, v16
    v_dot2_f32_bf16 v17, v34, v4, v17
    v_dot2_f32_bf16 v18, v38, v4, v18
    v_dot2_f32_bf16 v19, v42, v4, v19
    v_dot2_f32_bf16 v20, v46, v4, v20
    v_dot2_f32_bf16 v21, v50, v4, v21
    v_dot2_f32_bf16 v22, v54, v4, v22
    v_dot2_f32_bf16 v23, v58, v4, v23
    v_dot2_f32_bf16 v16, v31, v5, v16
    v_dot2_f32_bf16 v17, v35, v5, v17
    v_dot2_f32_bf16 v18, v39, v5, v18
    v_dot2_f32_bf16 v19, v43, v5, v19
    v_dot2_f32_bf16 v20, v47, v5, v20
    v_dot2_f32_bf16 v21, v51, v5, v21
    v_dot2_f32_bf16 v22, v55, v5, v22
    v_dot2_f32_bf16 v23, v59, v5, v23
    v_add_f32_dpp v16, v16, v16 row_mirror row_mask:0xf bank_mask:0x3
    v_add_f32_dpp v16, v20, v20 row_mirror row_mask:0xf bank_mask:0xc
    v_add_f32_dpp v17, v17, v17 row_mirror row_mask:0xf bank_mask:0x3
    v_add_f32_dpp v17, v21, v21 row_mirror row_mask:0xf bank_mask:0xc
    v_add_f32_dpp v18, v18, v18 row_mirror row_mask:0xf bank_mask:0x3
    v_add_f32_dpp v18, v22, v22 row_mirror row_mask:0xf bank_mask:0xc
    v_add_f32_dpp v19, v19, v19 row_mirror row_mask:0xf bank_mask:0x3
    v_add_f32_dpp v19, v23, v23 row_mirror row_mask:0xf bank_mask:0xc
    v_add_f32_dpp v16, v16, v16 row_half_mirror row_mask:0xf bank_mask:0x5
    v_add_f32_dpp v16, v18, v18 row_half_mirror row_mask:0xf bank_mask:0xa
    v_add_f32_dpp v17, v17, v17 row_half_mirror row_mask:0xf bank_mask:0x5
    v_add_f32_dpp v17, v19, v19 row_half_mirror row_mask:0xf bank_mask:0xa
    v_add_f32_dpp v16, v16, v16 quad_perm:[2,3,0,1] row_mask:0xf bank_mask:0xf
    s_nop 0
    v_add_f32_dpp v17, v17, v17 quad_perm:[2,3,0,1] row_mask:0xf bank_mask:0xf
    v_add_f32_dpp v16, v16, v16 quad_perm:[1,0,3,2] row_mask:0xf bank_mask:0xf
    s_nop 0
    v_add_f32_dpp v17, v17, v17 quad_perm:[1,0,3,2] row_mask:0xf bank_mask:0xf
    v_cvt_pk_bf16_f32 v18, v16, v17
    v_lshlrev_b32 v16, 16, v18
    v_and_b32 v17, 0xffff0000, v18
    v_mul_f32 v16, 0x3db504f3, v16
    v_mul_f32 v17, 0x3db504f3, v17
    v_cvt_pk_bf16_f32 v18, v16, v17
    v_lshlrev_b32 v16, 16, v18
    v_and_b32 v17, 0xffff0000, v18
    v_max_f32 v18, v16, v17
    s_nop 1
    v_max_f32_dpp v18, v18, v18 row_half_mirror row_mask:0xf bank_mask:0xf
    s_nop 1
    v_max_f32_dpp v18, v18, v18 row_mirror row_mask:0xf bank_mask:0xf
    v_max_f32 v18, v18, v14
    v_sub_f32 v19, v14, v18
    v_sub_f32 v16, v16, v18
    v_sub_f32 v17, v17, v18
    v_mul_f32 v19, 0x3fb8aa3b, v19
    v_mul_f32 v16, 0x3fb8aa3b, v16
    v_mul_f32 v17, 0x3fb8aa3b, v17
    v_exp_f32 v19, v19
    v_exp_f32 v16, v16
    v_exp_f32 v17, v17
    v_mov_b32 v14, v18
    v_cvt_pk_bf16_f32 v24, v16, 0
    v_cvt_pk_bf16_f32 v25, v17, 0
    v_fma_f32 v15, v15, v19, v16
    v_lshlrev_b32 v26, 16, v24
    v_lshlrev_b32 v27, 16, v25
    v_add_f32 v15, v15, v17
    v_mul_f32 v6, v6, v19
    v_mul_f32 v7, v7, v19
    v_mul_f32 v8, v8, v19
    v_mul_f32 v9, v9, v19
    v_mul_f32 v10, v10, v19
    v_mul_f32 v11, v11, v19
    v_mul_f32 v12, v12, v19
    v_mul_f32 v13, v13, v19
    s_waitcnt vmcnt(48)
    v_dot2c_f32_bf16_dpp v6, v24, v156 row_newbcast:0 row_mask:0xf bank_mask:0xf
    v_dot2c_f32_bf16_dpp v7, v26, v156 row_newbcast:0 row_mask:0xf bank_mask:0xf
    v_dot2c_f32_bf16_dpp v8, v24, v157 row_newbcast:0 row_mask:0xf bank_mask:0xf
    v_dot2c_f32_bf16_dpp v9, v26, v157 row_newbcast:0 row_mask:0xf bank_mask:0xf
    v_dot2c_f32_bf16_dpp v10, v24, v158 row_newbcast:0 row_mask:0xf bank_mask:0xf
    v_dot2c_f32_bf16_dpp v11, v26, v158 row_newbcast:0 row_mask:0xf bank_mask:0xf
    v_dot2c_f32_bf16_dpp v12, v24, v159 row_newbcast:0 row_mask:0xf bank_mask:0xf
    v_dot2c_f32_bf16_dpp v13, v26, v159 row_newbcast:0 row_mask:0xf bank_mask:0xf
    v_dot2c_f32_bf16_dpp v6, v25, v160 row_newbcast:0 row_mask:0xf bank_mask:0xf
    v_dot2c_f32_bf16_dpp v7, v27, v160 row_newbcast:0 row_mask:0xf bank_mask:0xf
    v_dot2c_f32_bf16_dpp v8, v25, v161 row_newbcast:0 row_mask:0xf bank_mask:0xf
    v_dot2c_f32_bf16_dpp v9, v27, v161 row_newbcast:0 row_mask:0xf bank_mask:0xf
    v_dot2c_f32_bf16_dpp v10, v25, v162 row_newbcast:0 row_mask:0xf bank_mask:0xf
    v_dot2c_f32_bf16_dpp v11, v27, v162 row_newbcast:0 row_mask:0xf bank_mask:0xf
    v_dot2c_f32_bf16_dpp v12, v25, v163 row_newbcast:0 row_mask:0xf bank_mask:0xf
    v_dot2c_f32_bf16_dpp v13, v27, v163 row_newbcast:0 row_mask:0xf bank_mask:0xf
    v_dot2c_f32_bf16_dpp v6, v24, v164 row_newbcast:4 row_mask:0xf bank_mask:0xf
    v_dot2c_f32_bf16_dpp v7, v26, v164 row_newbcast:4 row_mask:0xf bank_mask:0xf
    v_dot2c_f32_bf16_dpp v8, v24, v165 row_newbcast:4 row_mask:0xf bank_mask:0xf
    v_dot2c_f32_bf16_dpp v9, v26, v165 row_newbcast:4 row_mask:0xf bank_mask:0xf
    v_dot2c_f32_bf16_dpp v10, v24, v166 row_newbcast:4 row_mask:0xf bank_mask:0xf
    v_dot2c_f32_bf16_dpp v11, v26, v166 row_newbcast:4 row_mask:0xf bank_mask:0xf
    v_dot2c_f32_bf16_dpp v12, v24, v167 row_newbcast:4 row_mask:0xf bank_mask:0xf
    v_dot2c_f32_bf16_dpp v13, v26, v167 row_newbcast:4 row_mask:0xf bank_mask:0xf
    v_dot2c_f32_bf16_dpp v6, v25, v168 row_newbcast:4 row_mask:0xf bank_mask:0xf
    v_dot2c_f32_bf16_dpp v7, v27, v168 row_newbcast:4 row_mask:0xf bank_mask:0xf
    v_dot2c_f32_bf16_dpp v8, v25, v169 row_newbcast:4 row_mask:0xf bank_mask:0xf
    v_dot2c_f32_bf16_dpp v9, v27, v169 row_newbcast:4 row_mask:0xf bank_mask:0xf
    v_dot2c_f32_bf16_dpp v10, v25, v170 row_newbcast:4 row_mask:0xf bank_mask:0xf
    v_dot2c_f32_bf16_dpp v11, v27, v170 row_newbcast:4 row_mask:0xf bank_mask:0xf
    v_dot2c_f32_bf16_dpp v12, v25, v171 row_newbcast:4 row_mask:0xf bank_mask:0xf
    v_dot2c_f32_bf16_dpp v13, v27, v171 row_newbcast:4 row_mask:0xf bank_mask:0xf
    v_dot2c_f32_bf16_dpp v6, v24, v172 row_newbcast:8 row_mask:0xf bank_mask:0xf
    v_dot2c_f32_bf16_dpp v7, v26, v172 row_newbcast:8 row_mask:0xf bank_mask:0xf
    v_dot2c_f32_bf16_dpp v8, v24, v173 row_newbcast:8 row_mask:0xf bank_mask:0xf
    v_dot2c_f32_bf16_dpp v9, v26, v173 row_newbcast:8 row_mask:0xf bank_mask:0xf
    v_dot2c_f32_bf16_dpp v10, v24, v174 row_newbcast:8 row_mask:0xf bank_mask:0xf
    v_dot2c_f32_bf16_dpp v11, v26, v174 row_newbcast:8 row_mask:0xf bank_mask:0xf
    v_dot2c_f32_bf16_dpp v12, v24, v175 row_newbcast:8 row_mask:0xf bank_mask:0xf
    v_dot2c_f32_bf16_dpp v13, v26, v175 row_newbcast:8 row_mask:0xf bank_mask:0xf
    v_dot2c_f32_bf16_dpp v6, v25, v176 row_newbcast:8 row_mask:0xf bank_mask:0xf
    v_dot2c_f32_bf16_dpp v7, v27, v176 row_newbcast:8 row_mask:0xf bank_mask:0xf
    v_dot2c_f32_bf16_dpp v8, v25, v177 row_newbcast:8 row_mask:0xf bank_mask:0xf
    v_dot2c_f32_bf16_dpp v9, v27, v177 row_newbcast:8 row_mask:0xf bank_mask:0xf
    v_dot2c_f32_bf16_dpp v10, v25, v178 row_newbcast:8 row_mask:0xf bank_mask:0xf
    v_dot2c_f32_bf16_dpp v11, v27, v178 row_newbcast:8 row_mask:0xf bank_mask:0xf
    v_dot2c_f32_bf16_dpp v12, v25, v179 row_newbcast:8 row_mask:0xf bank_mask:0xf
    v_dot2c_f32_bf16_dpp v13, v27, v179 row_newbcast:8 row_mask:0xf bank_mask:0xf
    v_dot2c_f32_bf16_dpp v6, v24, v180 row_newbcast:12 row_mask:0xf bank_mask:0xf
    v_dot2c_f32_bf16_dpp v7, v26, v180 row_newbcast:12 row_mask:0xf bank_mask:0xf
    v_dot2c_f32_bf16_dpp v8, v24, v181 row_newbcast:12 row_mask:0xf bank_mask:0xf
    v_dot2c_f32_bf16_dpp v9, v26, v181 row_newbcast:12 row_mask:0xf bank_mask:0xf
    v_dot2c_f32_bf16_dpp v10, v24, v182 row_newbcast:12 row_mask:0xf bank_mask:0xf
    v_dot2c_f32_bf16_dpp v11, v26, v182 row_newbcast:12 row_mask:0xf bank_mask:0xf
    v_dot2c_f32_bf16_dpp v12, v24, v183 row_newbcast:12 row_mask:0xf bank_mask:0xf
    v_dot2c_f32_bf16_dpp v13, v26, v183 row_newbcast:12 row_mask:0xf bank_mask:0xf
    v_dot2c_f32_bf16_dpp v6, v25, v184 row_newbcast:12 row_mask:0xf bank_mask:0xf
    v_dot2c_f32_bf16_dpp v7, v27, v184 row_newbcast:12 row_mask:0xf bank_mask:0xf
    v_dot2c_f32_bf16_dpp v8, v25, v185 row_newbcast:12 row_mask:0xf bank_mask:0xf
    v_dot2c_f32_bf16_dpp v9, v27, v185 row_newbcast:12 row_mask:0xf bank_mask:0xf
    v_dot2c_f32_bf16_dpp v10, v25, v186 row_newbcast:12 row_mask:0xf bank_mask:0xf
    v_dot2c_f32_bf16_dpp v11, v27, v186 row_newbcast:12 row_mask:0xf bank_mask:0xf
    v_dot2c_f32_bf16_dpp v12, v25, v187 row_newbcast:12 row_mask:0xf bank_mask:0xf
    v_dot2c_f32_bf16_dpp v13, v27, v187 row_newbcast:12 row_mask:0xf bank_mask:0xf
    s_waitcnt vmcnt(40)
    v_dot2_f32_bf16 v16, v60, v2, 0
    v_dot2_f32_bf16 v17, v64, v2, 0
    v_dot2_f32_bf16 v18, v68, v2, 0
    v_dot2_f32_bf16 v19, v72, v2, 0
    v_dot2_f32_bf16 v20, v76, v2, 0
    v_dot2_f32_bf16 v21, v80, v2, 0
    v_dot2_f32_bf16 v22, v84, v2, 0
    v_dot2_f32_bf16 v23, v88, v2, 0
    v_dot2_f32_bf16 v16, v61, v3, v16
    v_dot2_f32_bf16 v17, v65, v3, v17
    v_dot2_f32_bf16 v18, v69, v3, v18
    v_dot2_f32_bf16 v19, v73, v3, v19
    v_dot2_f32_bf16 v20, v77, v3, v20
    v_dot2_f32_bf16 v21, v81, v3, v21
    v_dot2_f32_bf16 v22, v85, v3, v22
    v_dot2_f32_bf16 v23, v89, v3, v23
    v_dot2_f32_bf16 v16, v62, v4, v16
    v_dot2_f32_bf16 v17, v66, v4, v17
    v_dot2_f32_bf16 v18, v70, v4, v18
    v_dot2_f32_bf16 v19, v74, v4, v19
    v_dot2_f32_bf16 v20, v78, v4, v20
    v_dot2_f32_bf16 v21, v82, v4, v21
    v_dot2_f32_bf16 v22, v86, v4, v22
    v_dot2_f32_bf16 v23, v90, v4, v23
    v_dot2_f32_bf16 v16, v63, v5, v16
    v_dot2_f32_bf16 v17, v67, v5, v17
    v_dot2_f32_bf16 v18, v71, v5, v18
    v_dot2_f32_bf16 v19, v75, v5, v19
    v_dot2_f32_bf16 v20, v79, v5, v20
    v_dot2_f32_bf16 v21, v83, v5, v21
    v_dot2_f32_bf16 v22, v87, v5, v22
    v_dot2_f32_bf16 v23, v91, v5, v23
    v_add_f32_dpp v16, v16, v16 row_mirror row_mask:0xf bank_mask:0x3
    v_add_f32_dpp v16, v20, v20 row_mirror row_mask:0xf bank_mask:0xc
    v_add_f32_dpp v17, v17, v17 row_mirror row_mask:0xf bank_mask:0x3
    v_add_f32_dpp v17, v21, v21 row_mirror row_mask:0xf bank_mask:0xc
    v_add_f32_dpp v18, v18, v18 row_mirror row_mask:0xf bank_mask:0x3
    v_add_f32_dpp v18, v22, v22 row_mirror row_mask:0xf bank_mask:0xc
    v_add_f32_dpp v19, v19, v19 row_mirror row_mask:0xf bank_mask:0x3
    v_add_f32_dpp v19, v23, v23 row_mirror row_mask:0xf bank_mask:0xc
    v_add_f32_dpp v16, v16, v16 row_half_mirror row_mask:0xf bank_mask:0x5
    v_add_f32_dpp v16, v18, v18 row_half_mirror row_mask:0xf bank_mask:0xa
    v_add_f32_dpp v17, v17, v17 row_half_mirror row_mask:0xf bank_mask:0x5
    v_add_f32_dpp v17, v19, v19 row_half_mirror row_mask:0xf bank_mask:0xa
    v_add_f32_dpp v16, v16, v16 quad_perm:[2,3,0,1] row_mask:0xf bank_mask:0xf
    s_nop 0
    v_add_f32_dpp v17, v17, v17 quad_perm:[2,3,0,1] row_mask:0xf bank_mask:0xf
    v_add_f32_dpp v16, v16, v16 quad_perm:[1,0,3,2] row_mask:0xf bank_mask:0xf
    s_nop 0
    v_add_f32_dpp v17, v17, v17 quad_perm:[1,0,3,2] row_mask:0xf bank_mask:0xf
    v_cvt_pk_bf16_f32 v18, v16, v17
    v_lshlrev_b32 v16, 16, v18
    v_and_b32 v17, 0xffff0000, v18
    v_mul_f32 v16, 0x3db504f3, v16
    v_mul_f32 v17, 0x3db504f3, v17
    v_cvt_pk_bf16_f32 v18, v16, v17
    v_lshlrev_b32 v16, 16, v18
    v_and_b32 v17, 0xffff0000, v18
    v_max_f32 v18, v16, v17
    s_nop 1
    v_max_f32_dpp v18, v18, v18 row_half_mirror row_mask:0xf bank_mask:0xf
    s_nop 1
    v_max_f32_dpp v18, v18, v18 row_mirror row_mask:0xf bank_mask:0xf
    v_max_f32 v18, v18, v14
    v_sub_f32 v19, v14, v18
    v_sub_f32 v16, v16, v18
    v_sub_f32 v17, v17, v18
    v_mul_f32 v19, 0x3fb8aa3b, v19
    v_mul_f32 v16, 0x3fb8aa3b, v16
    v_mul_f32 v17, 0x3fb8aa3b, v17
    v_exp_f32 v19, v19
    v_exp_f32 v16, v16
    v_exp_f32 v17, v17
    v_mov_b32 v14, v18
    v_cvt_pk_bf16_f32 v24, v16, 0
    v_cvt_pk_bf16_f32 v25, v17, 0
    v_fma_f32 v15, v15, v19, v16
    v_lshlrev_b32 v26, 16, v24
    v_lshlrev_b32 v27, 16, v25
    v_add_f32 v15, v15, v17
    v_mul_f32 v6, v6, v19
    v_mul_f32 v7, v7, v19
    v_mul_f32 v8, v8, v19
    v_mul_f32 v9, v9, v19
    v_mul_f32 v10, v10, v19
    v_mul_f32 v11, v11, v19
    v_mul_f32 v12, v12, v19
    v_mul_f32 v13, v13, v19
    s_waitcnt vmcnt(32)
    v_dot2c_f32_bf16_dpp v6, v24, v188 row_newbcast:0 row_mask:0xf bank_mask:0xf
    v_dot2c_f32_bf16_dpp v7, v26, v188 row_newbcast:0 row_mask:0xf bank_mask:0xf
    v_dot2c_f32_bf16_dpp v8, v24, v189 row_newbcast:0 row_mask:0xf bank_mask:0xf
    v_dot2c_f32_bf16_dpp v9, v26, v189 row_newbcast:0 row_mask:0xf bank_mask:0xf
    v_dot2c_f32_bf16_dpp v10, v24, v190 row_newbcast:0 row_mask:0xf bank_mask:0xf
    v_dot2c_f32_bf16_dpp v11, v26, v190 row_newbcast:0 row_mask:0xf bank_mask:0xf
    v_dot2c_f32_bf16_dpp v12, v24, v191 row_newbcast:0 row_mask:0xf bank_mask:0xf
    v_dot2c_f32_bf16_dpp v13, v26, v191 row_newbcast:0 row_mask:0xf bank_mask:0xf
    v_dot2c_f32_bf16_dpp v6, v25, v192 row_newbcast:0 row_mask:0xf bank_mask:0xf
    v_dot2c_f32_bf16_dpp v7, v27, v192 row_newbcast:0 row_mask:0xf bank_mask:0xf
    v_dot2c_f32_bf16_dpp v8, v25, v193 row_newbcast:0 row_mask:0xf bank_mask:0xf
    v_dot2c_f32_bf16_dpp v9, v27, v193 row_newbcast:0 row_mask:0xf bank_mask:0xf
    v_dot2c_f32_bf16_dpp v10, v25, v194 row_newbcast:0 row_mask:0xf bank_mask:0xf
    v_dot2c_f32_bf16_dpp v11, v27, v194 row_newbcast:0 row_mask:0xf bank_mask:0xf
    v_dot2c_f32_bf16_dpp v12, v25, v195 row_newbcast:0 row_mask:0xf bank_mask:0xf
    v_dot2c_f32_bf16_dpp v13, v27, v195 row_newbcast:0 row_mask:0xf bank_mask:0xf
    v_dot2c_f32_bf16_dpp v6, v24, v196 row_newbcast:4 row_mask:0xf bank_mask:0xf
    v_dot2c_f32_bf16_dpp v7, v26, v196 row_newbcast:4 row_mask:0xf bank_mask:0xf
    v_dot2c_f32_bf16_dpp v8, v24, v197 row_newbcast:4 row_mask:0xf bank_mask:0xf
    v_dot2c_f32_bf16_dpp v9, v26, v197 row_newbcast:4 row_mask:0xf bank_mask:0xf
    v_dot2c_f32_bf16_dpp v10, v24, v198 row_newbcast:4 row_mask:0xf bank_mask:0xf
    v_dot2c_f32_bf16_dpp v11, v26, v198 row_newbcast:4 row_mask:0xf bank_mask:0xf
    v_dot2c_f32_bf16_dpp v12, v24, v199 row_newbcast:4 row_mask:0xf bank_mask:0xf
    v_dot2c_f32_bf16_dpp v13, v26, v199 row_newbcast:4 row_mask:0xf bank_mask:0xf
    v_dot2c_f32_bf16_dpp v6, v25, v200 row_newbcast:4 row_mask:0xf bank_mask:0xf
    v_dot2c_f32_bf16_dpp v7, v27, v200 row_newbcast:4 row_mask:0xf bank_mask:0xf
    v_dot2c_f32_bf16_dpp v8, v25, v201 row_newbcast:4 row_mask:0xf bank_mask:0xf
    v_dot2c_f32_bf16_dpp v9, v27, v201 row_newbcast:4 row_mask:0xf bank_mask:0xf
    v_dot2c_f32_bf16_dpp v10, v25, v202 row_newbcast:4 row_mask:0xf bank_mask:0xf
    v_dot2c_f32_bf16_dpp v11, v27, v202 row_newbcast:4 row_mask:0xf bank_mask:0xf
    v_dot2c_f32_bf16_dpp v12, v25, v203 row_newbcast:4 row_mask:0xf bank_mask:0xf
    v_dot2c_f32_bf16_dpp v13, v27, v203 row_newbcast:4 row_mask:0xf bank_mask:0xf
    v_dot2c_f32_bf16_dpp v6, v24, v204 row_newbcast:8 row_mask:0xf bank_mask:0xf
    v_dot2c_f32_bf16_dpp v7, v26, v204 row_newbcast:8 row_mask:0xf bank_mask:0xf
    v_dot2c_f32_bf16_dpp v8, v24, v205 row_newbcast:8 row_mask:0xf bank_mask:0xf
    v_dot2c_f32_bf16_dpp v9, v26, v205 row_newbcast:8 row_mask:0xf bank_mask:0xf
    v_dot2c_f32_bf16_dpp v10, v24, v206 row_newbcast:8 row_mask:0xf bank_mask:0xf
    v_dot2c_f32_bf16_dpp v11, v26, v206 row_newbcast:8 row_mask:0xf bank_mask:0xf
    v_dot2c_f32_bf16_dpp v12, v24, v207 row_newbcast:8 row_mask:0xf bank_mask:0xf
    v_dot2c_f32_bf16_dpp v13, v26, v207 row_newbcast:8 row_mask:0xf bank_mask:0xf
    v_dot2c_f32_bf16_dpp v6, v25, v208 row_newbcast:8 row_mask:0xf bank_mask:0xf
    v_dot2c_f32_bf16_dpp v7, v27, v208 row_newbcast:8 row_mask:0xf bank_mask:0xf
    v_dot2c_f32_bf16_dpp v8, v25, v209 row_newbcast:8 row_mask:0xf bank_mask:0xf
    v_dot2c_f32_bf16_dpp v9, v27, v209 row_newbcast:8 row_mask:0xf bank_mask:0xf
    v_dot2c_f32_bf16_dpp v10, v25, v210 row_newbcast:8 row_mask:0xf bank_mask:0xf
    v_dot2c_f32_bf16_dpp v11, v27, v210 row_newbcast:8 row_mask:0xf bank_mask:0xf
    v_dot2c_f32_bf16_dpp v12, v25, v211 row_newbcast:8 row_mask:0xf bank_mask:0xf
    v_dot2c_f32_bf16_dpp v13, v27, v211 row_newbcast:8 row_mask:0xf bank_mask:0xf
    v_dot2c_f32_bf16_dpp v6, v24, v212 row_newbcast:12 row_mask:0xf bank_mask:0xf
    v_dot2c_f32_bf16_dpp v7, v26, v212 row_newbcast:12 row_mask:0xf bank_mask:0xf
    v_dot2c_f32_bf16_dpp v8, v24, v213 row_newbcast:12 row_mask:0xf bank_mask:0xf
    v_dot2c_f32_bf16_dpp v9, v26, v213 row_newbcast:12 row_mask:0xf bank_mask:0xf
    v_dot2c_f32_bf16_dpp v10, v24, v214 row_newbcast:12 row_mask:0xf bank_mask:0xf
    v_dot2c_f32_bf16_dpp v11, v26, v214 row_newbcast:12 row_mask:0xf bank_mask:0xf
    v_dot2c_f32_bf16_dpp v12, v24, v215 row_newbcast:12 row_mask:0xf bank_mask:0xf
    v_dot2c_f32_bf16_dpp v13, v26, v215 row_newbcast:12 row_mask:0xf bank_mask:0xf
    v_dot2c_f32_bf16_dpp v6, v25, v216 row_newbcast:12 row_mask:0xf bank_mask:0xf
    v_dot2c_f32_bf16_dpp v7, v27, v216 row_newbcast:12 row_mask:0xf bank_mask:0xf
    v_dot2c_f32_bf16_dpp v8, v25, v217 row_newbcast:12 row_mask:0xf bank_mask:0xf
    v_dot2c_f32_bf16_dpp v9, v27, v217 row_newbcast:12 row_mask:0xf bank_mask:0xf
    v_dot2c_f32_bf16_dpp v10, v25, v218 row_newbcast:12 row_mask:0xf bank_mask:0xf
    v_dot2c_f32_bf16_dpp v11, v27, v218 row_newbcast:12 row_mask:0xf bank_mask:0xf
    v_dot2c_f32_bf16_dpp v12, v25, v219 row_newbcast:12 row_mask:0xf bank_mask:0xf
    v_dot2c_f32_bf16_dpp v13, v27, v219 row_newbcast:12 row_mask:0xf bank_mask:0xf
    s_waitcnt vmcnt(24)
    v_dot2_f32_bf16 v16, v92, v2, 0
    v_dot2_f32_bf16 v17, v96, v2, 0
    v_dot2_f32_bf16 v18, v100, v2, 0
    v_dot2_f32_bf16 v19, v104, v2, 0
    v_dot2_f32_bf16 v20, v108, v2, 0
    v_dot2_f32_bf16 v21, v112, v2, 0
    v_dot2_f32_bf16 v22, v116, v2, 0
    v_dot2_f32_bf16 v23, v120, v2, 0
    v_dot2_f32_bf16 v16, v93, v3, v16
    v_dot2_f32_bf16 v17, v97, v3, v17
    v_dot2_f32_bf16 v18, v101, v3, v18
    v_dot2_f32_bf16 v19, v105, v3, v19
    v_dot2_f32_bf16 v20, v109, v3, v20
    v_dot2_f32_bf16 v21, v113, v3, v21
    v_dot2_f32_bf16 v22, v117, v3, v22
    v_dot2_f32_bf16 v23, v121, v3, v23
    v_dot2_f32_bf16 v16, v94, v4, v16
    v_dot2_f32_bf16 v17, v98, v4, v17
    v_dot2_f32_bf16 v18, v102, v4, v18
    v_dot2_f32_bf16 v19, v106, v4, v19
    v_dot2_f32_bf16 v20, v110, v4, v20
    v_dot2_f32_bf16 v21, v114, v4, v21
    v_dot2_f32_bf16 v22, v118, v4, v22
    v_dot2_f32_bf16 v23, v122, v4, v23
    v_dot2_f32_bf16 v16, v95, v5, v16
    v_dot2_f32_bf16 v17, v99, v5, v17
    v_dot2_f32_bf16 v18, v103, v5, v18
    v_dot2_f32_bf16 v19, v107, v5, v19
    v_dot2_f32_bf16 v20, v111, v5, v20
    v_dot2_f32_bf16 v21, v115, v5, v21
    v_dot2_f32_bf16 v22, v119, v5, v22
    v_dot2_f32_bf16 v23, v123, v5, v23
    v_add_f32_dpp v16, v16, v16 row_mirror row_mask:0xf bank_mask:0x3
    v_add_f32_dpp v16, v20, v20 row_mirror row_mask:0xf bank_mask:0xc
    v_add_f32_dpp v17, v17, v17 row_mirror row_mask:0xf bank_mask:0x3
    v_add_f32_dpp v17, v21, v21 row_mirror row_mask:0xf bank_mask:0xc
    v_add_f32_dpp v18, v18, v18 row_mirror row_mask:0xf bank_mask:0x3
    v_add_f32_dpp v18, v22, v22 row_mirror row_mask:0xf bank_mask:0xc
    v_add_f32_dpp v19, v19, v19 row_mirror row_mask:0xf bank_mask:0x3
    v_add_f32_dpp v19, v23, v23 row_mirror row_mask:0xf bank_mask:0xc
    v_add_f32_dpp v16, v16, v16 row_half_mirror row_mask:0xf bank_mask:0x5
    v_add_f32_dpp v16, v18, v18 row_half_mirror row_mask:0xf bank_mask:0xa
    v_add_f32_dpp v17, v17, v17 row_half_mirror row_mask:0xf bank_mask:0x5
    v_add_f32_dpp v17, v19, v19 row_half_mirror row_mask:0xf bank_mask:0xa
    v_add_f32_dpp v16, v16, v16 quad_perm:[2,3,0,1] row_mask:0xf bank_mask:0xf
    s_nop 0
    v_add_f32_dpp v17, v17, v17 quad_perm:[2,3,0,1] row_mask:0xf bank_mask:0xf
    v_add_f32_dpp v16, v16, v16 quad_perm:[1,0,3,2] row_mask:0xf bank_mask:0xf
    s_nop 0
    v_add_f32_dpp v17, v17, v17 quad_perm:[1,0,3,2] row_mask:0xf bank_mask:0xf
    v_cvt_pk_bf16_f32 v18, v16, v17
    v_lshlrev_b32 v16, 16, v18
    v_and_b32 v17, 0xffff0000, v18
    v_mul_f32 v16, 0x3db504f3, v16
    v_mul_f32 v17, 0x3db504f3, v17
    v_cvt_pk_bf16_f32 v18, v16, v17
    v_lshlrev_b32 v16, 16, v18
    v_and_b32 v17, 0xffff0000, v18
    v_max_f32 v18, v16, v17
    s_nop 1
    v_max_f32_dpp v18, v18, v18 row_half_mirror row_mask:0xf bank_mask:0xf
    s_nop 1
    v_max_f32_dpp v18, v18, v18 row_mirror row_mask:0xf bank_mask:0xf
    v_max_f32 v18, v18, v14
    v_sub_f32 v19, v14, v18
    v_sub_f32 v16, v16, v18
    v_sub_f32 v17, v17, v18
    v_mul_f32 v19, 0x3fb8aa3b, v19
    v_mul_f32 v16, 0x3fb8aa3b, v16
    v_mul_f32 v17, 0x3fb8aa3b, v17
    v_exp_f32 v19, v19
    v_exp_f32 v16, v16
    v_exp_f32 v17, v17
    v_mov_b32 v14, v18
    v_cvt_pk_bf16_f32 v24, v16, 0
    v_cvt_pk_bf16_f32 v25, v17, 0
    v_fma_f32 v15, v15, v19, v16
    v_lshlrev_b32 v26, 16, v24
    v_lshlrev_b32 v27, 16, v25
    v_add_f32 v15, v15, v17
    v_mul_f32 v6, v6, v19
    v_mul_f32 v7, v7, v19
    v_mul_f32 v8, v8, v19
    v_mul_f32 v9, v9, v19
    v_mul_f32 v10, v10, v19
    v_mul_f32 v11, v11, v19
    v_mul_f32 v12, v12, v19
    v_mul_f32 v13, v13, v19
    s_waitcnt vmcnt(16)
    v_dot2c_f32_bf16_dpp v6, v24, v220 row_newbcast:0 row_mask:0xf bank_mask:0xf
    v_dot2c_f32_bf16_dpp v7, v26, v220 row_newbcast:0 row_mask:0xf bank_mask:0xf
    v_dot2c_f32_bf16_dpp v8, v24, v221 row_newbcast:0 row_mask:0xf bank_mask:0xf
    v_dot2c_f32_bf16_dpp v9, v26, v221 row_newbcast:0 row_mask:0xf bank_mask:0xf
    v_dot2c_f32_bf16_dpp v10, v24, v222 row_newbcast:0 row_mask:0xf bank_mask:0xf
    v_dot2c_f32_bf16_dpp v11, v26, v222 row_newbcast:0 row_mask:0xf bank_mask:0xf
    v_dot2c_f32_bf16_dpp v12, v24, v223 row_newbcast:0 row_mask:0xf bank_mask:0xf
    v_dot2c_f32_bf16_dpp v13, v26, v223 row_newbcast:0 row_mask:0xf bank_mask:0xf
    v_dot2c_f32_bf16_dpp v6, v25, v224 row_newbcast:0 row_mask:0xf bank_mask:0xf
    v_dot2c_f32_bf16_dpp v7, v27, v224 row_newbcast:0 row_mask:0xf bank_mask:0xf
    v_dot2c_f32_bf16_dpp v8, v25, v225 row_newbcast:0 row_mask:0xf bank_mask:0xf
    v_dot2c_f32_bf16_dpp v9, v27, v225 row_newbcast:0 row_mask:0xf bank_mask:0xf
    v_dot2c_f32_bf16_dpp v10, v25, v226 row_newbcast:0 row_mask:0xf bank_mask:0xf
    v_dot2c_f32_bf16_dpp v11, v27, v226 row_newbcast:0 row_mask:0xf bank_mask:0xf
    v_dot2c_f32_bf16_dpp v12, v25, v227 row_newbcast:0 row_mask:0xf bank_mask:0xf
    v_dot2c_f32_bf16_dpp v13, v27, v227 row_newbcast:0 row_mask:0xf bank_mask:0xf
    v_dot2c_f32_bf16_dpp v6, v24, v228 row_newbcast:4 row_mask:0xf bank_mask:0xf
    v_dot2c_f32_bf16_dpp v7, v26, v228 row_newbcast:4 row_mask:0xf bank_mask:0xf
    v_dot2c_f32_bf16_dpp v8, v24, v229 row_newbcast:4 row_mask:0xf bank_mask:0xf
    v_dot2c_f32_bf16_dpp v9, v26, v229 row_newbcast:4 row_mask:0xf bank_mask:0xf
    v_dot2c_f32_bf16_dpp v10, v24, v230 row_newbcast:4 row_mask:0xf bank_mask:0xf
    v_dot2c_f32_bf16_dpp v11, v26, v230 row_newbcast:4 row_mask:0xf bank_mask:0xf
    v_dot2c_f32_bf16_dpp v12, v24, v231 row_newbcast:4 row_mask:0xf bank_mask:0xf
    v_dot2c_f32_bf16_dpp v13, v26, v231 row_newbcast:4 row_mask:0xf bank_mask:0xf
    v_dot2c_f32_bf16_dpp v6, v25, v232 row_newbcast:4 row_mask:0xf bank_mask:0xf
    v_dot2c_f32_bf16_dpp v7, v27, v232 row_newbcast:4 row_mask:0xf bank_mask:0xf
    v_dot2c_f32_bf16_dpp v8, v25, v233 row_newbcast:4 row_mask:0xf bank_mask:0xf
    v_dot2c_f32_bf16_dpp v9, v27, v233 row_newbcast:4 row_mask:0xf bank_mask:0xf
    v_dot2c_f32_bf16_dpp v10, v25, v234 row_newbcast:4 row_mask:0xf bank_mask:0xf
    v_dot2c_f32_bf16_dpp v11, v27, v234 row_newbcast:4 row_mask:0xf bank_mask:0xf
    v_dot2c_f32_bf16_dpp v12, v25, v235 row_newbcast:4 row_mask:0xf bank_mask:0xf
    v_dot2c_f32_bf16_dpp v13, v27, v235 row_newbcast:4 row_mask:0xf bank_mask:0xf
    v_dot2c_f32_bf16_dpp v6, v24, v236 row_newbcast:8 row_mask:0xf bank_mask:0xf
    v_dot2c_f32_bf16_dpp v7, v26, v236 row_newbcast:8 row_mask:0xf bank_mask:0xf
    v_dot2c_f32_bf16_dpp v8, v24, v237 row_newbcast:8 row_mask:0xf bank_mask:0xf
    v_dot2c_f32_bf16_dpp v9, v26, v237 row_newbcast:8 row_mask:0xf bank_mask:0xf
    v_dot2c_f32_bf16_dpp v10, v24, v238 row_newbcast:8 row_mask:0xf bank_mask:0xf
    v_dot2c_f32_bf16_dpp v11, v26, v238 row_newbcast:8 row_mask:0xf bank_mask:0xf
    v_dot2c_f32_bf16_dpp v12, v24, v239 row_newbcast:8 row_mask:0xf bank_mask:0xf
    v_dot2c_f32_bf16_dpp v13, v26, v239 row_newbcast:8 row_mask:0xf bank_mask:0xf
    v_dot2c_f32_bf16_dpp v6, v25, v240 row_newbcast:8 row_mask:0xf bank_mask:0xf
    v_dot2c_f32_bf16_dpp v7, v27, v240 row_newbcast:8 row_mask:0xf bank_mask:0xf
    v_dot2c_f32_bf16_dpp v8, v25, v241 row_newbcast:8 row_mask:0xf bank_mask:0xf
    v_dot2c_f32_bf16_dpp v9, v27, v241 row_newbcast:8 row_mask:0xf bank_mask:0xf
    v_dot2c_f32_bf16_dpp v10, v25, v242 row_newbcast:8 row_mask:0xf bank_mask:0xf
    v_dot2c_f32_bf16_dpp v11, v27, v242 row_newbcast:8 row_mask:0xf bank_mask:0xf
    v_dot2c_f32_bf16_dpp v12, v25, v243 row_newbcast:8 row_mask:0xf bank_mask:0xf
    v_dot2c_f32_bf16_dpp v13, v27, v243 row_newbcast:8 row_mask:0xf bank_mask:0xf
    v_dot2c_f32_bf16_dpp v6, v24, v244 row_newbcast:12 row_mask:0xf bank_mask:0xf
    v_dot2c_f32_bf16_dpp v7, v26, v244 row_newbcast:12 row_mask:0xf bank_mask:0xf
    v_dot2c_f32_bf16_dpp v8, v24, v245 row_newbcast:12 row_mask:0xf bank_mask:0xf
    v_dot2c_f32_bf16_dpp v9, v26, v245 row_newbcast:12 row_mask:0xf bank_mask:0xf
    v_dot2c_f32_bf16_dpp v10, v24, v246 row_newbcast:12 row_mask:0xf bank_mask:0xf
    v_dot2c_f32_bf16_dpp v11, v26, v246 row_newbcast:12 row_mask:0xf bank_mask:0xf
    v_dot2c_f32_bf16_dpp v12, v24, v247 row_newbcast:12 row_mask:0xf bank_mask:0xf
    v_dot2c_f32_bf16_dpp v13, v26, v247 row_newbcast:12 row_mask:0xf bank_mask:0xf
    v_dot2c_f32_bf16_dpp v6, v25, v248 row_newbcast:12 row_mask:0xf bank_mask:0xf
    v_dot2c_f32_bf16_dpp v7, v27, v248 row_newbcast:12 row_mask:0xf bank_mask:0xf
    v_dot2c_f32_bf16_dpp v8, v25, v249 row_newbcast:12 row_mask:0xf bank_mask:0xf
    v_dot2c_f32_bf16_dpp v9, v27, v249 row_newbcast:12 row_mask:0xf bank_mask:0xf
    v_dot2c_f32_bf16_dpp v10, v25, v250 row_newbcast:12 row_mask:0xf bank_mask:0xf
    v_dot2c_f32_bf16_dpp v11, v27, v250 row_newbcast:12 row_mask:0xf bank_mask:0xf
    v_dot2c_f32_bf16_dpp v12, v25, v251 row_newbcast:12 row_mask:0xf bank_mask:0xf
    v_dot2c_f32_bf16_dpp v13, v27, v251 row_newbcast:12 row_mask:0xf bank_mask:0xf
    s_waitcnt vmcnt(8)
    v_dot2_f32_bf16 v16, v124, v2, 0
    v_dot2_f32_bf16 v17, v128, v2, 0
    v_dot2_f32_bf16 v18, v132, v2, 0
    v_dot2_f32_bf16 v19, v136, v2, 0
    v_dot2_f32_bf16 v20, v140, v2, 0
    v_dot2_f32_bf16 v21, v144, v2, 0
    v_dot2_f32_bf16 v22, v148, v2, 0
    v_dot2_f32_bf16 v23, v152, v2, 0
    v_dot2_f32_bf16 v16, v125, v3, v16
    v_dot2_f32_bf16 v17, v129, v3, v17
    v_dot2_f32_bf16 v18, v133, v3, v18
    v_dot2_f32_bf16 v19, v137, v3, v19
    v_dot2_f32_bf16 v20, v141, v3, v20
    v_dot2_f32_bf16 v21, v145, v3, v21
    v_dot2_f32_bf16 v22, v149, v3, v22
    v_dot2_f32_bf16 v23, v153, v3, v23
    v_dot2_f32_bf16 v16, v126, v4, v16
    v_dot2_f32_bf16 v17, v130, v4, v17
    v_dot2_f32_bf16 v18, v134, v4, v18
    v_dot2_f32_bf16 v19, v138, v4, v19
    v_dot2_f32_bf16 v20, v142, v4, v20
    v_dot2_f32_bf16 v21, v146, v4, v21
    v_dot2_f32_bf16 v22, v150, v4, v22
    v_dot2_f32_bf16 v23, v154, v4, v23
    v_dot2_f32_bf16 v16, v127, v5, v16
    v_dot2_f32_bf16 v17, v131, v5, v17
    v_dot2_f32_bf16 v18, v135, v5, v18
    v_dot2_f32_bf16 v19, v139, v5, v19
    v_dot2_f32_bf16 v20, v143, v5, v20
    v_dot2_f32_bf16 v21, v147, v5, v21
    v_dot2_f32_bf16 v22, v151, v5, v22
    v_dot2_f32_bf16 v23, v155, v5, v23
    v_add_f32_dpp v16, v16, v16 row_mirror row_mask:0xf bank_mask:0x3
    v_add_f32_dpp v16, v20, v20 row_mirror row_mask:0xf bank_mask:0xc
    v_add_f32_dpp v17, v17, v17 row_mirror row_mask:0xf bank_mask:0x3
    v_add_f32_dpp v17, v21, v21 row_mirror row_mask:0xf bank_mask:0xc
    v_add_f32_dpp v18, v18, v18 row_mirror row_mask:0xf bank_mask:0x3
    v_add_f32_dpp v18, v22, v22 row_mirror row_mask:0xf bank_mask:0xc
    v_add_f32_dpp v19, v19, v19 row_mirror row_mask:0xf bank_mask:0x3
    v_add_f32_dpp v19, v23, v23 row_mirror row_mask:0xf bank_mask:0xc
    v_add_f32_dpp v16, v16, v16 row_half_mirror row_mask:0xf bank_mask:0x5
    v_add_f32_dpp v16, v18, v18 row_half_mirror row_mask:0xf bank_mask:0xa
    v_add_f32_dpp v17, v17, v17 row_half_mirror row_mask:0xf bank_mask:0x5
    v_add_f32_dpp v17, v19, v19 row_half_mirror row_mask:0xf bank_mask:0xa
    v_add_f32_dpp v16, v16, v16 quad_perm:[2,3,0,1] row_mask:0xf bank_mask:0xf
    s_nop 0
    v_add_f32_dpp v17, v17, v17 quad_perm:[2,3,0,1] row_mask:0xf bank_mask:0xf
    v_add_f32_dpp v16, v16, v16 quad_perm:[1,0,3,2] row_mask:0xf bank_mask:0xf
    s_nop 0
    v_add_f32_dpp v17, v17, v17 quad_perm:[1,0,3,2] row_mask:0xf bank_mask:0xf
    v_cvt_pk_bf16_f32 v18, v16, v17
    v_lshlrev_b32 v16, 16, v18
    v_and_b32 v17, 0xffff0000, v18
    v_mul_f32 v16, 0x3db504f3, v16
    v_mul_f32 v17, 0x3db504f3, v17
    v_cvt_pk_bf16_f32 v18, v16, v17
    v_lshlrev_b32 v16, 16, v18
    v_and_b32 v17, 0xffff0000, v18
    v_max_f32 v18, v16, v17
    s_nop 1
    v_max_f32_dpp v18, v18, v18 row_half_mirror row_mask:0xf bank_mask:0xf
    s_nop 1
    v_max_f32_dpp v18, v18, v18 row_mirror row_mask:0xf bank_mask:0xf
    v_max_f32 v18, v18, v14
    v_sub_f32 v19, v14, v18
    v_sub_f32 v16, v16, v18
    v_sub_f32 v17, v17, v18
    v_mul_f32 v19, 0x3fb8aa3b, v19
    v_mul_f32 v16, 0x3fb8aa3b, v16
    v_mul_f32 v17, 0x3fb8aa3b, v17
    v_exp_f32 v19, v19
    v_exp_f32 v16, v16
    v_exp_f32 v17, v17
    v_mov_b32 v14, v18
    v_cvt_pk_bf16_f32 v24, v16, 0
    v_cvt_pk_bf16_f32 v25, v17, 0
    v_fma_f32 v15, v15, v19, v16
    v_lshlrev_b32 v26, 16, v24
    v_lshlrev_b32 v27, 16, v25
    v_add_f32 v15, v15, v17
    v_mul_f32 v6, v6, v19
    v_mul_f32 v7, v7, v19
    v_mul_f32 v8, v8, v19
    v_mul_f32 v9, v9, v19
    v_mul_f32 v10, v10, v19
    v_mul_f32 v11, v11, v19
    v_mul_f32 v12, v12, v19
    v_mul_f32 v13, v13, v19
    s_waitcnt vmcnt(0)
    v_dot2c_f32_bf16_dpp v6, v24, v252 row_newbcast:0 row_mask:0xf bank_mask:0xf
    v_dot2c_f32_bf16_dpp v7, v26, v252 row_newbcast:0 row_mask:0xf bank_mask:0xf
    v_dot2c_f32_bf16_dpp v8, v24, v253 row_newbcast:0 row_mask:0xf bank_mask:0xf
    v_dot2c_f32_bf16_dpp v9, v26, v253 row_newbcast:0 row_mask:0xf bank_mask:0xf
    v_dot2c_f32_bf16_dpp v10, v24, v254 row_newbcast:0 row_mask:0xf bank_mask:0xf
    v_dot2c_f32_bf16_dpp v11, v26, v254 row_newbcast:0 row_mask:0xf bank_mask:0xf
    v_dot2c_f32_bf16_dpp v12, v24, v255 row_newbcast:0 row_mask:0xf bank_mask:0xf
    v_dot2c_f32_bf16_dpp v13, v26, v255 row_newbcast:0 row_mask:0xf bank_mask:0xf
    ds_read_b128 v[18:21], v1 offset:0
    s_waitcnt lgkmcnt(0)
    v_dot2c_f32_bf16_dpp v6, v25, v18 row_newbcast:0 row_mask:0xf bank_mask:0xf
    v_dot2c_f32_bf16_dpp v7, v27, v18 row_newbcast:0 row_mask:0xf bank_mask:0xf
    v_dot2c_f32_bf16_dpp v8, v25, v19 row_newbcast:0 row_mask:0xf bank_mask:0xf
    v_dot2c_f32_bf16_dpp v9, v27, v19 row_newbcast:0 row_mask:0xf bank_mask:0xf
    v_dot2c_f32_bf16_dpp v10, v25, v20 row_newbcast:0 row_mask:0xf bank_mask:0xf
    v_dot2c_f32_bf16_dpp v11, v27, v20 row_newbcast:0 row_mask:0xf bank_mask:0xf
    v_dot2c_f32_bf16_dpp v12, v25, v21 row_newbcast:0 row_mask:0xf bank_mask:0xf
    v_dot2c_f32_bf16_dpp v13, v27, v21 row_newbcast:0 row_mask:0xf bank_mask:0xf
    ds_read_b128 v[18:21], v1 offset:1024
    s_waitcnt lgkmcnt(0)
    v_dot2c_f32_bf16_dpp v6, v24, v18 row_newbcast:4 row_mask:0xf bank_mask:0xf
    v_dot2c_f32_bf16_dpp v7, v26, v18 row_newbcast:4 row_mask:0xf bank_mask:0xf
    v_dot2c_f32_bf16_dpp v8, v24, v19 row_newbcast:4 row_mask:0xf bank_mask:0xf
    v_dot2c_f32_bf16_dpp v9, v26, v19 row_newbcast:4 row_mask:0xf bank_mask:0xf
    v_dot2c_f32_bf16_dpp v10, v24, v20 row_newbcast:4 row_mask:0xf bank_mask:0xf
    v_dot2c_f32_bf16_dpp v11, v26, v20 row_newbcast:4 row_mask:0xf bank_mask:0xf
    v_dot2c_f32_bf16_dpp v12, v24, v21 row_newbcast:4 row_mask:0xf bank_mask:0xf
    v_dot2c_f32_bf16_dpp v13, v26, v21 row_newbcast:4 row_mask:0xf bank_mask:0xf
    ds_read_b128 v[18:21], v1 offset:2048
    s_waitcnt lgkmcnt(0)
    v_dot2c_f32_bf16_dpp v6, v25, v18 row_newbcast:4 row_mask:0xf bank_mask:0xf
    v_dot2c_f32_bf16_dpp v7, v27, v18 row_newbcast:4 row_mask:0xf bank_mask:0xf
    v_dot2c_f32_bf16_dpp v8, v25, v19 row_newbcast:4 row_mask:0xf bank_mask:0xf
    v_dot2c_f32_bf16_dpp v9, v27, v19 row_newbcast:4 row_mask:0xf bank_mask:0xf
    v_dot2c_f32_bf16_dpp v10, v25, v20 row_newbcast:4 row_mask:0xf bank_mask:0xf
    v_dot2c_f32_bf16_dpp v11, v27, v20 row_newbcast:4 row_mask:0xf bank_mask:0xf
    v_dot2c_f32_bf16_dpp v12, v25, v21 row_newbcast:4 row_mask:0xf bank_mask:0xf
    v_dot2c_f32_bf16_dpp v13, v27, v21 row_newbcast:4 row_mask:0xf bank_mask:0xf
    ds_read_b128 v[18:21], v1 offset:3072
    s_waitcnt lgkmcnt(0)
    v_dot2c_f32_bf16_dpp v6, v24, v18 row_newbcast:8 row_mask:0xf bank_mask:0xf
    v_dot2c_f32_bf16_dpp v7, v26, v18 row_newbcast:8 row_mask:0xf bank_mask:0xf
    v_dot2c_f32_bf16_dpp v8, v24, v19 row_newbcast:8 row_mask:0xf bank_mask:0xf
    v_dot2c_f32_bf16_dpp v9, v26, v19 row_newbcast:8 row_mask:0xf bank_mask:0xf
    v_dot2c_f32_bf16_dpp v10, v24, v20 row_newbcast:8 row_mask:0xf bank_mask:0xf
    v_dot2c_f32_bf16_dpp v11, v26, v20 row_newbcast:8 row_mask:0xf bank_mask:0xf
    v_dot2c_f32_bf16_dpp v12, v24, v21 row_newbcast:8 row_mask:0xf bank_mask:0xf
    v_dot2c_f32_bf16_dpp v13, v26, v21 row_newbcast:8 row_mask:0xf bank_mask:0xf
    ds_read_b128 v[18:21], v1 offset:4096
    s_waitcnt lgkmcnt(0)
    v_dot2c_f32_bf16_dpp v6, v25, v18 row_newbcast:8 row_mask:0xf bank_mask:0xf
    v_dot2c_f32_bf16_dpp v7, v27, v18 row_newbcast:8 row_mask:0xf bank_mask:0xf
    v_dot2c_f32_bf16_dpp v8, v25, v19 row_newbcast:8 row_mask:0xf bank_mask:0xf
    v_dot2c_f32_bf16_dpp v9, v27, v19 row_newbcast:8 row_mask:0xf bank_mask:0xf
    v_dot2c_f32_bf16_dpp v10, v25, v20 row_newbcast:8 row_mask:0xf bank_mask:0xf
    v_dot2c_f32_bf16_dpp v11, v27, v20 row_newbcast:8 row_mask:0xf bank_mask:0xf
    v_dot2c_f32_bf16_dpp v12, v25, v21 row_newbcast:8 row_mask:0xf bank_mask:0xf
    v_dot2c_f32_bf16_dpp v13, v27, v21 row_newbcast:8 row_mask:0xf bank_mask:0xf
    ds_read_b128 v[18:21], v1 offset:5120
    s_waitcnt lgkmcnt(0)
    v_dot2c_f32_bf16_dpp v6, v24, v18 row_newbcast:12 row_mask:0xf bank_mask:0xf
    v_dot2c_f32_bf16_dpp v7, v26, v18 row_newbcast:12 row_mask:0xf bank_mask:0xf
    v_dot2c_f32_bf16_dpp v8, v24, v19 row_newbcast:12 row_mask:0xf bank_mask:0xf
    v_dot2c_f32_bf16_dpp v9, v26, v19 row_newbcast:12 row_mask:0xf bank_mask:0xf
    v_dot2c_f32_bf16_dpp v10, v24, v20 row_newbcast:12 row_mask:0xf bank_mask:0xf
    v_dot2c_f32_bf16_dpp v11, v26, v20 row_newbcast:12 row_mask:0xf bank_mask:0xf
    v_dot2c_f32_bf16_dpp v12, v24, v21 row_newbcast:12 row_mask:0xf bank_mask:0xf
    v_dot2c_f32_bf16_dpp v13, v26, v21 row_newbcast:12 row_mask:0xf bank_mask:0xf
    ds_read_b128 v[18:21], v1 offset:6144
    s_waitcnt lgkmcnt(0)
    v_dot2c_f32_bf16_dpp v6, v25, v18 row_newbcast:12 row_mask:0xf bank_mask:0xf
    v_dot2c_f32_bf16_dpp v7, v27, v18 row_newbcast:12 row_mask:0xf bank_mask:0xf
    v_dot2c_f32_bf16_dpp v8, v25, v19 row_newbcast:12 row_mask:0xf bank_mask:0xf
    v_dot2c_f32_bf16_dpp v9, v27, v19 row_newbcast:12 row_mask:0xf bank_mask:0xf
    v_dot2c_f32_bf16_dpp v10, v25, v20 row_newbcast:12 row_mask:0xf bank_mask:0xf
    v_dot2c_f32_bf16_dpp v11, v27, v20 row_newbcast:12 row_mask:0xf bank_mask:0xf
    v_dot2c_f32_bf16_dpp v12, v25, v21 row_newbcast:12 row_mask:0xf bank_mask:0xf
    v_dot2c_f32_bf16_dpp v13, v27, v21 row_newbcast:12 row_mask:0xf bank_mask:0xf
    v_mov_b32 v16, v14
    v_mov_b32 v17, v14
    s_nop 1
    v_permlane16_swap_b32 v16, v17
    v_max_f32 v16, v16, v17
    v_mov_b32 v17, v16
    s_nop 1
    v_permlane32_swap_b32 v16, v17
    v_max_f32 v16, v16, v17
    v_sub_f32 v17, v14, v16
    v_mul_f32 v17, 0x3fb8aa3b, v17
    v_exp_f32 v17, v17
    s_nop 0
    v_mul_f32 v15, v15, v17
    v_mul_f32 v6, v6, v17
    v_mul_f32 v7, v7, v17
    v_mul_f32 v8, v8, v17
    v_mul_f32 v9, v9, v17
    v_mul_f32 v10, v10, v17
    v_mul_f32 v11, v11, v17
    v_mul_f32 v12, v12, v17
    v_mul_f32 v13, v13, v17
    v_add_f32_dpp v15, v15, v15 row_half_mirror row_mask:0xf bank_mask:0xf
    s_nop 1
    v_add_f32_dpp v15, v15, v15 row_mirror row_mask:0xf bank_mask:0xf
    v_mov_b32 v17, v15
    s_nop 1
    v_permlane16_swap_b32 v15, v17
    v_add_f32 v15, v15, v17
    v_mov_b32 v17, v15
    s_nop 1
    v_permlane32_swap_b32 v15, v17
    v_add_f32 v15, v15, v17
    v_permlane32_swap_b32 v6, v10
    v_permlane32_swap_b32 v7, v11
    v_permlane32_swap_b32 v8, v12
    v_permlane32_swap_b32 v9, v13
    v_add_f32 v6, v6, v10
    v_add_f32 v7, v7, v11
    v_add_f32 v8, v8, v12
    v_add_f32 v9, v9, v13
    s_nop 0
    v_permlane16_swap_b32 v6, v8
    v_permlane16_swap_b32 v7, v9
    v_add_f32 v6, v6, v8
    v_add_f32 v7, v7, v9
    v_mbcnt_lo_u32_b32 v18, -1, 0
    v_mbcnt_hi_u32_b32 v18, -1, v18
    v_and_b32 v19, 15, v18
    v_lshlrev_b32 v19, 5, v19
    v_lshrrev_b32 v17, 4, v18
    v_lshl_add_u32 v19, v17, 3, v19
    s_lshl_b32 s32, s24, 9
    s_add_u32 s32, s32, 147456
    v_add_u32 v19, s32, v19
    ds_write_b64 v19, v[6:7]
    v_mov_b32 v8, v16
    v_mov_b32 v9, v15
    s_lshl_b32 s32, s24, 3
    s_add_u32 s32, s32, 151552
    v_mov_b32 v19, s32
    ds_write_b64 v19, v[8:9]
    s_waitcnt lgkmcnt(0)
    s_barrier
    s_cmp_ge_u32 s24, 2
    s_cbranch_scc1 ep_skip_22
    v_mbcnt_lo_u32_b32 v26, -1, 0
    v_mbcnt_hi_u32_b32 v26, -1, v26
    s_lshl_b32 s32, s24, 8
    s_add_u32 s32, s32, 147456
    v_lshlrev_b32 v26, 2, v26
    v_add_u32 v26, s32, v26
    v_mov_b32 v27, 151552
    ds_read_b32 v2, v26 offset:0
    ds_read_b32 v3, v26 offset:512
    ds_read_b32 v4, v26 offset:1024
    ds_read_b32 v5, v26 offset:1536
    ds_read_b32 v6, v26 offset:2048
    ds_read_b32 v7, v26 offset:2560
    ds_read_b32 v8, v26 offset:3072
    ds_read_b32 v9, v26 offset:3584
    ds_read_b128 v[10:13], v27 offset:0
    ds_read_b128 v[14:17], v27 offset:16
    ds_read_b128 v[18:21], v27 offset:32
    ds_read_b128 v[22:25], v27 offset:48
    s_waitcnt lgkmcnt(0)
    v_max3_f32 v26, v10, v12, v14
    v_max3_f32 v26, v26, v16, v18
    v_max3_f32 v26, v26, v20, v22
    v_max_f32 v26, v26, v24
    v_sub_f32 v10, v10, v26
    v_sub_f32 v12, v12, v26
    v_sub_f32 v14, v14, v26
    v_sub_f32 v16, v16, v26
    v_sub_f32 v18, v18, v26
    v_sub_f32 v20, v20, v26
    v_sub_f32 v22, v22, v26
    v_sub_f32 v24, v24, v26
    v_mul_f32 v10, 0x3fb8aa3b, v10
    v_mul_f32 v12, 0x3fb8aa3b, v12
    v_mul_f32 v14, 0x3fb8aa3b, v14
    v_mul_f32 v16, 0x3fb8aa3b, v16
    v_mul_f32 v18, 0x3fb8aa3b, v18
    v_mul_f32 v20, 0x3fb8aa3b, v20
    v_mul_f32 v22, 0x3fb8aa3b, v22
    v_mul_f32 v24, 0x3fb8aa3b, v24
    v_exp_f32 v10, v10
    v_exp_f32 v12, v12
    v_exp_f32 v14, v14
    v_exp_f32 v16, v16
    v_exp_f32 v18, v18
    v_exp_f32 v20, v20
    v_exp_f32 v22, v22
    v_exp_f32 v24, v24
    v_mul_f32 v2, v2, v10
    v_mul_f32 v27, v11, v10
    v_fma_f32 v2, v3, v12, v2
    v_fma_f32 v27, v13, v12, v27
    v_fma_f32 v2, v4, v14, v2
    v_fma_f32 v27, v15, v14, v27
    v_fma_f32 v2, v5, v16, v2
    v_fma_f32 v27, v17, v16, v27
    v_fma_f32 v2, v6, v18, v2
    v_fma_f32 v27, v19, v18, v27
    v_fma_f32 v2, v7, v20, v2
    v_fma_f32 v27, v21, v20, v27
    v_fma_f32 v2, v8, v22, v2
    v_fma_f32 v27, v23, v22, v27
    v_fma_f32 v2, v9, v24, v2
    v_fma_f32 v27, v25, v24, v27
    v_mbcnt_lo_u32_b32 v3, -1, 0
    v_mbcnt_hi_u32_b32 v3, -1, v3
    v_lshlrev_b32 v4, 2, v3
    s_mul_i32 s32, s21, 576
    s_add_u32 s32, s32, s29
    s_lshl_b32 s33, s24, 8
    s_add_u32 s33, s33, s32
    buffer_store_dword v2, v4, s[12:15], s33 offen offset:0
    s_cmp_lg_u32 s24, 0
    s_cbranch_scc1 ep_skip_22
    v_cmp_eq_u32 vcc, 0, v3
    s_and_saveexec_b64 s[36:37], vcc
    buffer_store_dwordx2 v[26:27], v4, s[12:15], s32 offen offset:512
    s_mov_b64 exec, -1
ep_skip_22:
    s_nop 3
noatt1_13:
    s_nop 3
    s_lshl_b32 s32, s26, 2
    s_sub_u32 s32, 4, s32
    s_cmp_lg_u32 s27, s32
    s_cselect_b32 s54, 1, 0
    s_cmp_eq_u32 s25, 0
    s_cselect_b32 s55, s54, 0
    v_mbcnt_lo_u32_b32 v27, -1, 0
    v_mbcnt_hi_u32_b32 v27, -1, v27
    s_cmp_eq_u32 s54, 0
    s_cbranch_scc1 nos1a_23
    v_lshlrev_b32 v26, 3, v27
    v_mov_b32 v25, 0
    s_lshl_b32 s32, s96, 2
    s_add_u32 s32, s32, s25
    s_mul_i32 s32, s32, 2304
    s_add_u32 s32, s32, s28
poll_24:
    s_nop 3
    buffer_load_dwordx2 v[2:3], v26, s[12:15], s32 offen offset:0 sc1
    buffer_load_dwordx2 v[10:11], v25, s[12:15], s32 offen offset:512 sc1
    buffer_load_dwordx2 v[4:5], v26, s[12:15], s32 offen offset:576 sc1
    buffer_load_dwordx2 v[12:13], v25, s[12:15], s32 offen offset:1088 sc1
    buffer_load_dwordx2 v[6:7], v26, s[12:15], s32 offen offset:1152 sc1
    buffer_load_dwordx2 v[14:15], v25, s[12:15], s32 offen offset:1664 sc1
    buffer_load_dwordx2 v[8:9], v26, s[12:15], s32 offen offset:1728 sc1
    buffer_load_dwordx2 v[16:17], v25, s[12:15], s32 offen offset:2240 sc1
    s_waitcnt vmcnt(0)
    v_max3_u32 v24, v2, v3, v4
    v_max3_u32 v24, v24, v5, v6
    v_max3_u32 v24, v24, v7, v8
    v_max3_u32 v24, v24, v9, v10
    v_max3_u32 v24, v24, v11, v12
    v_max3_u32 v24, v24, v13, v14
    v_max3_u32 v24, v24, v15, v16
    v_max_u32 v24, v24, v17
    v_cmp_eq_u32 vcc, -1, v24
    s_cbranch_vccz polld_25
    s_sleep 1
    s_sub_u32 s31, s31, 1
    s_cbranch_scc0 poll_24
    s_branch main_bail
polld_25:
    s_nop 3
    v_max3_f32 v24, v10, v12, v14
    v_max_f32 v24, v24, v16
    v_sub_f32 v10, v10, v24
    v_sub_f32 v12, v12, v24
    v_sub_f32 v14, v14, v24
    v_sub_f32 v16, v16, v24
    v_mul_f32 v10, 0x3fb8aa3b, v10
    v_mul_f32 v12, 0x3fb8aa3b, v12
    v_mul_f32 v14, 0x3fb8aa3b, v14
    v_mul_f32 v16, 0x3fb8aa3b, v16
    v_exp_f32 v10, v10
    v_exp_f32 v12, v12
    v_exp_f32 v14, v14
    v_exp_f32 v16, v16
    v_mul_f32 v24, v11, v10
    v_mul_f32 v2, v2, v10
    v_mul_f32 v3, v3, v10
    v_fma_f32 v24, v13, v12, v24
    v_fma_f32 v2, v4, v12, v2
    v_fma_f32 v3, v5, v12, v3
    v_fma_f32 v24, v15, v14, v24
    v_fma_f32 v2, v6, v14, v2
    v_fma_f32 v3, v7, v14, v3
    v_fma_f32 v24, v17, v16, v24
    v_fma_f32 v2, v8, v16, v2
    v_fma_f32 v3, v9, v16, v3
    v_rcp_f32 v24, v24
    s_nop 0
    v_mul_f32 v2, v2, v24
    v_mul_f32 v3, v3, v24
    v_cvt_pk_bf16_f32 v2, v2, v3
    s_lshl_b32 s32, s24, 8
    s_add_u32 s32, s32, 156928
    v_lshlrev_b32 v26, 2, v27
    v_add_u32 v26, s32, v26
    ds_write_b32 v26, v2
    s_waitcnt lgkmcnt(0)
nos1a_23:
    s_nop 3
    s_barrier
    s_cmp_eq_u32 s54, 0
    s_cbranch_scc1 na1_26
    s_lshl_b32 s32, s26, 10
    s_add_u32 s32, s32, 156928
    v_add_u32 v26, s32, v0
    ds_read_b128 v[2:5], v26
    s_lshl_b32 s32, s25, 10
    s_add_u32 s32, s32, 57344
    v_add_u32 v26, s32, v0
    ds_read_b128 v[14:17], v26 offset:0
    ds_read_b128 v[18:21], v26 offset:4096
    s_waitcnt lgkmcnt(0)
    v_dot2_f32_bf16 v6, v14, v2, 0
    v_dot2_f32_bf16 v7, v15, v2, 0
    v_dot2_f32_bf16 v8, v16, v2, 0
    v_dot2_f32_bf16 v9, v17, v2, 0
    v_dot2_f32_bf16 v10, v18, v2, 0
    v_dot2_f32_bf16 v11, v19, v2, 0
    v_dot2_f32_bf16 v12, v20, v2, 0
    v_dot2_f32_bf16 v13, v21, v2, 0
    ds_read_b128 v[14:17], v26 offset:8192
    ds_read_b128 v[18:21], v26 offset:12288
    s_waitcnt lgkmcnt(0)
    v_dot2_f32_bf16 v6, v14, v3, v6
    v_dot2_f32_bf16 v7, v15, v3, v7
    v_dot2_f32_bf16 v8, v16, v3, v8
    v_dot2_f32_bf16 v9, v17, v3, v9
    v_dot2_f32_bf16 v10, v18, v3, v10
    v_dot2_f32_bf16 v11, v19, v3, v11
    v_dot2_f32_bf16 v12, v20, v3, v12
    v_dot2_f32_bf16 v13, v21, v3, v13
    ds_read_b128 v[14:17], v26 offset:16384
    ds_read_b128 v[18:21], v26 offset:20480
    s_waitcnt lgkmcnt(0)
    v_dot2_f32_bf16 v6, v14, v4, v6
    v_dot2_f32_bf16 v7, v15, v4, v7
    v_dot2_f32_bf16 v8, v16, v4, v8
    v_dot2_f32_bf16 v9, v17, v4, v9
    v_dot2_f32_bf16 v10, v18, v4, v10
    v_dot2_f32_bf16 v11, v19, v4, v11
    v_dot2_f32_bf16 v12, v20, v4, v12
    v_dot2_f32_bf16 v13, v21, v4, v13
    ds_read_b128 v[14:17], v26 offset:24576
    ds_read_b128 v[18:21], v26 offset:28672
    s_waitcnt lgkmcnt(0)
    v_dot2_f32_bf16 v6, v14, v5, v6
    v_dot2_f32_bf16 v7, v15, v5, v7
    v_dot2_f32_bf16 v8, v16, v5, v8
    v_dot2_f32_bf16 v9, v17, v5, v9
    v_dot2_f32_bf16 v10, v18, v5, v10
    v_dot2_f32_bf16 v11, v19, v5, v11
    v_dot2_f32_bf16 v12, v20, v5, v12
    v_dot2_f32_bf16 v13, v21, v5, v13
    v_permlane32_swap_b32 v6, v8
    v_permlane32_swap_b32 v7, v9
    v_add_f32 v6, v6, v8
    v_add_f32 v7, v7, v9
    s_nop 1
    v_permlane16_swap_b32 v6, v7
    v_add_f32 v6, v6, v7
    s_nop 1
    v_add_f32_dpp v6, v6, v6 row_ror:8 row_mask:0xf bank_mask:0xf
    s_nop 1
    v_add_f32_dpp v6, v6, v6 row_ror:4 row_mask:0xf bank_mask:0xf
    s_nop 1
    v_add_f32_dpp v6, v6, v6 row_ror:2 row_mask:0xf bank_mask:0xf
    s_nop 1
    v_add_f32_dpp v6, v6, v6 row_ror:1 row_mask:0xf bank_mask:0xf
    v_permlane32_swap_b32 v10, v12
    v_permlane32_swap_b32 v11, v13
    v_add_f32 v10, v10, v12
    v_add_f32 v11, v11, v13
    s_nop 1
    v_permlane16_swap_b32 v10, v11
    v_add_f32 v10, v10, v11
    s_nop 1
    v_add_f32_dpp v10, v10, v10 row_ror:8 row_mask:0xf bank_mask:0xf
    s_nop 1
    v_add_f32_dpp v10, v10, v10 row_ror:4 row_mask:0xf bank_mask:0xf
    s_nop 1
    v_add_f32_dpp v10, v10, v10 row_ror:2 row_mask:0xf bank_mask:0xf
    s_nop 1
    v_add_f32_dpp v10, v10, v10 row_ror:1 row_mask:0xf bank_mask:0xf
    v_readlane_b32 s40, v6, 0
    v_readlane_b32 s41, v6, 16
    v_readlane_b32 s42, v6, 32
    v_readlane_b32 s43, v6, 48
    v_readlane_b32 s44, v10, 0
    v_readlane_b32 s45, v10, 16
    v_readlane_b32 s46, v10, 32
    v_readlane_b32 s47, v10, 48
    v_mov_b32 v14, s40
    v_mov_b32 v15, s41
    v_mov_b32 v16, s42
    v_mov_b32 v17, s43
    v_mov_b32 v18, s44
    v_mov_b32 v19, s45
    v_mov_b32 v20, s46
    v_mov_b32 v21, s47
    v_lshlrev_b32 v26, 10, v0
    s_lshl_b32 s32, s97, 10
    s_lshl_b32 s33, s96, 7
    s_add_u32 s32, s32, s33
    s_lshl_b32 s33, s25, 5
    s_add_u32 s32, s32, s33
    s_add_u32 s32, s32, s28
    s_add_u32 s32, s32, 73728
    s_mov_b64 exec, 0xff
    buffer_store_dwordx4 v[14:17], v26, s[12:15], s32 offen sc1
    buffer_store_dwordx4 v[18:21], v26, s[12:15], s32 offen offset:16 sc1
    s_mov_b64 exec, -1
    s_cmp_eq_u32 s55, 0
    s_cbranch_scc1 na1_26
    v_and_b32 v26, 7, v27
    s_cmp_eq_u32 s26, 1
    s_cbranch_scc1 res1_27
    s_lshl_b32 s32, s27, 1
    s_add_u32 s32, s32, s20
    s_lshl_b32 s32, s32, 10
    s_lshl_b32 s33, s97, 6
    s_add_u32 s32, s32, s33
    v_lshlrev_b32 v25, 3, v26
    buffer_load_dwordx2 v[14:15], v25, s[16:19], s32 offen
    s_waitcnt vmcnt(0)
    v_lshlrev_b32 v10, 16, v14
    v_and_b32 v11, 0xffff0000, v14
    v_lshlrev_b32 v12, 16, v15
    v_and_b32 v13, 0xffff0000, v15
    s_branch resd_28
res1_27:
    s_nop 3
    v_lshlrev_b32 v25, 4, v26
    v_add_u32 v25, 156672, v25
    ds_read_b128 v[10:13], v25
    s_waitcnt lgkmcnt(0)
resd_28:
    s_nop 3
    s_lshl_b32 s32, s21, 10
    s_add_u32 s32, s32, s28
    s_add_u32 s32, s32, 73728
poll_29:
    s_nop 3
    buffer_load_dwordx4 v[4:7], v0, s[12:15], s32 offen sc1
    s_waitcnt vmcnt(0)
    v_max3_u32 v24, v4, v5, v6
    v_max_u32 v24, v24, v7
    v_cmp_eq_u32 vcc, -1, v24
    s_cbranch_vccz polld_30
    s_sleep 1
    s_sub_u32 s31, s31, 1
    s_cbranch_scc0 poll_29
    s_branch main_bail
polld_30:
    s_nop 3
    v_mov_b32 v8, v4
    s_nop 1
    v_permlane32_swap_b32 v4, v8
    v_add_f32 v4, v4, v8
    v_mov_b32 v8, v5
    s_nop 1
    v_permlane32_swap_b32 v5, v8
    v_add_f32 v5, v5, v8
    v_mov_b32 v8, v6
    s_nop 1
    v_permlane32_swap_b32 v6, v8
    v_add_f32 v6, v6, v8
    v_mov_b32 v8, v7
    s_nop 1
    v_permlane32_swap_b32 v7, v8
    v_add_f32 v7, v7, v8
    v_mov_b32 v8, v4
    s_nop 1
    v_permlane16_swap_b32 v4, v8
    v_add_f32 v4, v4, v8
    v_mov_b32 v8, v5
    s_nop 1
    v_permlane16_swap_b32 v5, v8
    v_add_f32 v5, v5, v8
    v_mov_b32 v8, v6
    s_nop 1
    v_permlane16_swap_b32 v6, v8
    v_add_f32 v6, v6, v8
    v_mov_b32 v8, v7
    s_nop 1
    v_permlane16_swap_b32 v7, v8
    v_add_f32 v7, v7, v8
    v_add_f32_dpp v4, v4, v4 row_ror:8 row_mask:0xf bank_mask:0xf
    v_add_f32_dpp v5, v5, v5 row_ror:8 row_mask:0xf bank_mask:0xf
    v_add_f32_dpp v6, v6, v6 row_ror:8 row_mask:0xf bank_mask:0xf
    v_add_f32_dpp v7, v7, v7 row_ror:8 row_mask:0xf bank_mask:0xf
    v_cvt_pk_bf16_f32 v8, v4, v5
    v_lshlrev_b32 v4, 16, v8
    v_and_b32 v5, 0xffff0000, v8
    v_cvt_pk_bf16_f32 v8, v6, v7
    v_lshlrev_b32 v6, 16, v8
    v_and_b32 v7, 0xffff0000, v8
    v_add_f32 v10, v10, v4
    v_add_f32 v11, v11, v5
    v_add_f32 v12, v12, v6
    v_add_f32 v13, v13, v7
    v_cvt_pk_bf16_f32 v14, v10, v11
    v_cvt_pk_bf16_f32 v15, v12, v13
    v_lshlrev_b32 v10, 16, v14
    v_and_b32 v11, 0xffff0000, v14
    v_lshlrev_b32 v12, 16, v15
    v_and_b32 v13, 0xffff0000, v15
    s_lshl_b32 s32, s26, 7
    s_add_u32 s32, s32, 162304
    v_lshlrev_b32 v25, 4, v26
    v_add_u32 v25, s32, v25
    ds_write_b128 v25, v[10:13]
    v_lshlrev_b32 v24, 3, v26
    s_lshl_b32 s32, s96, 10
    s_lshl_b32 s33, s97, 6
    s_add_u32 s32, s32, s33
    s_add_u32 s32, s32, s28
    s_add_u32 s32, s32, 204800
    s_mov_b64 exec, 0xff
    buffer_store_dwordx2 v[14:15], v24, s[12:15], s32 offen
    s_mov_b64 exec, -1
    s_cmp_ge_u32 s21, 115
    s_cbranch_scc1 na1_26
    s_lshl_b32 s32, s96, 10
    s_add_u32 s32, s32, s28
    s_add_u32 s32, s32, 204800
poll_31:
    s_nop 3
    buffer_load_dwordx4 v[2:5], v0, s[12:15], s32 offen sc1
    s_waitcnt vmcnt(0)
    v_max3_u32 v24, v2, v3, v4
    v_max_u32 v24, v24, v5
    v_cmp_eq_u32 vcc, -1, v24
    s_cbranch_vccz polld_32
    s_sleep 1
    s_sub_u32 s31, s31, 1
    s_cbranch_scc0 poll_31
    s_branch main_bail
polld_32:
    s_nop 3
    v_lshlrev_b32 v10, 16, v2
    v_and_b32 v11, 0xffff0000, v2
    v_lshlrev_b32 v12, 16, v3
    v_and_b32 v13, 0xffff0000, v3
    v_lshlrev_b32 v14, 16, v4
    v_and_b32 v15, 0xffff0000, v4
    v_lshlrev_b32 v16, 16, v5
    v_and_b32 v17, 0xffff0000, v5
    v_add_f32 v22, v10, v11
    v_add_f32 v22, v22, v12
    v_add_f32 v22, v22, v13
    v_add_f32 v22, v22, v14
    v_add_f32 v22, v22, v15
    v_add_f32 v22, v22, v16
    v_add_f32 v22, v22, v17
    s_nop 1
    v_add_f32_dpp v22, v22, v22 row_ror:8 row_mask:0xf bank_mask:0xf
    s_nop 1
    v_add_f32_dpp v22, v22, v22 row_ror:4 row_mask:0xf bank_mask:0xf
    s_nop 1
    v_add_f32_dpp v22, v22, v22 row_ror:2 row_mask:0xf bank_mask:0xf
    s_nop 1
    v_add_f32_dpp v22, v22, v22 row_ror:1 row_mask:0xf bank_mask:0xf
    v_mov_b32 v23, v22
    s_nop 1
    v_permlane16_swap_b32 v22, v23
    v_add_f32 v22, v22, v23
    v_mov_b32 v23, v22
    s_nop 1
    v_permlane32_swap_b32 v22, v23
    v_add_f32 v22, v22, v23
    v_mul_f32 v22, 0x3b000000, v22
    v_sub_f32 v24, v10, v22
    v_mul_f32 v23, v24, v24
    v_sub_f32 v24, v11, v22
    v_fma_f32 v23, v24, v24, v23
    v_sub_f32 v24, v12, v22
    v_fma_f32 v23, v24, v24, v23
    v_sub_f32 v24, v13, v22
    v_fma_f32 v23, v24, v24, v23
    v_sub_f32 v24, v14, v22
    v_fma_f32 v23, v24, v24, v23
    v_sub_f32 v24, v15, v22
    v_fma_f32 v23, v24, v24, v23
    v_sub_f32 v24, v16, v22
    v_fma_f32 v23, v24, v24, v23
    v_sub_f32 v24, v17, v22
    v_fma_f32 v23, v24, v24, v23
    s_nop 1
    v_add_f32_dpp v23, v23, v23 row_ror:8 row_mask:0xf bank_mask:0xf
    s_nop 1
    v_add_f32_dpp v23, v23, v23 row_ror:4 row_mask:0xf bank_mask:0xf
    s_nop 1
    v_add_f32_dpp v23, v23, v23 row_ror:2 row_mask:0xf bank_mask:0xf
    s_nop 1
    v_add_f32_dpp v23, v23, v23 row_ror:1 row_mask:0xf bank_mask:0xf
    v_mov_b32 v24, v23
    s_nop 1
    v_permlane16_swap_b32 v23, v24
    v_add_f32 v23, v23, v24
    v_mov_b32 v24, v23
    s_nop 1
    v_permlane32_swap_b32 v23, v24
    v_add_f32 v23, v23, v24
    v_mul_f32 v23, 0x3b000000, v23
    v_cvt_pk_bf16_f32 v24, v22, v23
    v_lshlrev_b32 v22, 16, v24
    v_and_b32 v23, 0xffff0000, v24
    v_add_f32 v23, 0x3727c5ac, v23
    v_cvt_pk_bf16_f32 v24, v23, v23
    v_lshlrev_b32 v23, 16, v24
    v_sqrt_f32 v23, v23
    s_nop 0
    v_cvt_pk_bf16_f32 v24, v23, v23
    v_lshlrev_b32 v23, 16, v24
    v_rcp_f32 v23, v23
    v_sub_f32 v10, v10, v22
    v_sub_f32 v11, v11, v22
    v_cvt_pk_bf16_f32 v24, v10, v11
    v_lshlrev_b32 v10, 16, v24
    v_and_b32 v11, 0xffff0000, v24
    v_mul_f32 v10, v10, v23
    v_mul_f32 v11, v11, v23
    v_cvt_pk_bf16_f32 v18, v10, v11
    v_sub_f32 v12, v12, v22
    v_sub_f32 v13, v13, v22
    v_cvt_pk_bf16_f32 v24, v12, v13
    v_lshlrev_b32 v12, 16, v24
    v_and_b32 v13, 0xffff0000, v24
    v_mul_f32 v12, v12, v23
    v_mul_f32 v13, v13, v23
    v_cvt_pk_bf16_f32 v19, v12, v13
    v_sub_f32 v14, v14, v22
    v_sub_f32 v15, v15, v22
    v_cvt_pk_bf16_f32 v24, v14, v15
    v_lshlrev_b32 v14, 16, v24
    v_and_b32 v15, 0xffff0000, v24
    v_mul_f32 v14, v14, v23
    v_mul_f32 v15, v15, v23
    v_cvt_pk_bf16_f32 v20, v14, v15
    v_sub_f32 v16, v16, v22
    v_sub_f32 v17, v17, v22
    v_cvt_pk_bf16_f32 v24, v16, v17
    v_lshlrev_b32 v16, 16, v24
    v_and_b32 v17, 0xffff0000, v24
    v_mul_f32 v16, v16, v23
    v_mul_f32 v17, v17, v23
    v_cvt_pk_bf16_f32 v21, v16, v17
    s_lshl_b32 s32, s26, 10
    s_add_u32 s32, s32, 158976
    v_add_u32 v26, s32, v0
    ds_write_b128 v26, v[18:21]
na1_26:
    s_nop 3
    s_waitcnt lgkmcnt(0)
    s_barrier
    s_cmp_eq_u32 s54, 0
    s_cbranch_scc1 na2_33
    v_mov_b32 v2, 0
    v_mov_b32 v3, 0
    s_cmp_ge_u32 s21, 115
    s_cbranch_scc1 zpub_34
    s_lshl_b32 s32, s26, 10
    s_add_u32 s32, s32, 158976
    v_add_u32 v26, s32, v0
    ds_read_b128 v[10:13], v26
    v_add_u32 v26, 122880, v0
    ds_read_b128 v[22:25], v26 offset:0
    s_waitcnt lgkmcnt(0)
    v_dot2_f32_bf16 v2, v22, v10, 0
    v_dot2_f32_bf16 v3, v23, v10, 0
    v_dot2_f32_bf16 v4, v24, v10, 0
    v_dot2_f32_bf16 v5, v25, v10, 0
    ds_read_b128 v[22:25], v26 offset:1024
    s_waitcnt lgkmcnt(0)
    v_dot2_f32_bf16 v6, v22, v10, 0
    v_dot2_f32_bf16 v7, v23, v10, 0
    v_dot2_f32_bf16 v8, v24, v10, 0
    v_dot2_f32_bf16 v9, v25, v10, 0
    ds_read_b128 v[22:25], v26 offset:2048
    s_waitcnt lgkmcnt(0)
    v_dot2_f32_bf16 v14, v22, v10, 0
    v_dot2_f32_bf16 v15, v23, v10, 0
    v_dot2_f32_bf16 v16, v24, v10, 0
    v_dot2_f32_bf16 v17, v25, v10, 0
    ds_read_b128 v[22:25], v26 offset:3072
    s_waitcnt lgkmcnt(0)
    v_dot2_f32_bf16 v2, v22, v11, v2
    v_dot2_f32_bf16 v3, v23, v11, v3
    v_dot2_f32_bf16 v4, v24, v11, v4
    v_dot2_f32_bf16 v5, v25, v11, v5
    ds_read_b128 v[22:25], v26 offset:4096
    s_waitcnt lgkmcnt(0)
    v_dot2_f32_bf16 v6, v22, v11, v6
    v_dot2_f32_bf16 v7, v23, v11, v7
    v_dot2_f32_bf16 v8, v24, v11, v8
    v_dot2_f32_bf16 v9, v25, v11, v9
    ds_read_b128 v[22:25], v26 offset:5120
    s_waitcnt lgkmcnt(0)
    v_dot2_f32_bf16 v14, v22, v11, v14
    v_dot2_f32_bf16 v15, v23, v11, v15
    v_dot2_f32_bf16 v16, v24, v11, v16
    v_dot2_f32_bf16 v17, v25, v11, v17
    ds_read_b128 v[22:25], v26 offset:6144
    s_waitcnt lgkmcnt(0)
    v_dot2_f32_bf16 v2, v22, v12, v2
    v_dot2_f32_bf16 v3, v23, v12, v3
    v_dot2_f32_bf16 v4, v24, v12, v4
    v_dot2_f32_bf16 v5, v25, v12, v5
    ds_read_b128 v[22:25], v26 offset:7168
    s_waitcnt lgkmcnt(0)
    v_dot2_f32_bf16 v6, v22, v12, v6
    v_dot2_f32_bf16 v7, v23, v12, v7
    v_dot2_f32_bf16 v8, v24, v12, v8
    v_dot2_f32_bf16 v9, v25, v12, v9
    ds_read_b128 v[22:25], v26 offset:8192
    s_waitcnt lgkmcnt(0)
    v_dot2_f32_bf16 v14, v22, v12, v14
    v_dot2_f32_bf16 v15, v23, v12, v15
    v_dot2_f32_bf16 v16, v24, v12, v16
    v_dot2_f32_bf16 v17, v25, v12, v17
    ds_read_b128 v[22:25], v26 offset:9216
    s_waitcnt lgkmcnt(0)
    v_dot2_f32_bf16 v2, v22, v13, v2
    v_dot2_f32_bf16 v3, v23, v13, v3
    v_dot2_f32_bf16 v4, v24, v13, v4
    v_dot2_f32_bf16 v5, v25, v13, v5
    ds_read_b128 v[22:25], v26 offset:10240
    s_waitcnt lgkmcnt(0)
    v_dot2_f32_bf16 v6, v22, v13, v6
    v_dot2_f32_bf16 v7, v23, v13, v7
    v_dot2_f32_bf16 v8, v24, v13, v8
    v_dot2_f32_bf16 v9, v25, v13, v9
    ds_read_b128 v[22:25], v26 offset:11264
    s_waitcnt lgkmcnt(0)
    v_dot2_f32_bf16 v14, v22, v13, v14
    v_dot2_f32_bf16 v15, v23, v13, v15
    v_dot2_f32_bf16 v16, v24, v13, v16
    v_dot2_f32_bf16 v17, v25, v13, v17
    v_permlane32_swap_b32 v2, v4
    v_permlane32_swap_b32 v3, v5
    v_add_f32 v2, v2, v4
    v_add_f32 v3, v3, v5
    s_nop 1
    v_permlane16_swap_b32 v2, v3
    v_add_f32 v2, v2, v3
    s_nop 1
    v_add_f32_dpp v2, v2, v2 row_ror:8 row_mask:0xf bank_mask:0xf
    s_nop 1
    v_add_f32_dpp v2, v2, v2 row_ror:4 row_mask:0xf bank_mask:0xf
    s_nop 1
    v_add_f32_dpp v2, v2, v2 row_ror:2 row_mask:0xf bank_mask:0xf
    s_nop 1
    v_add_f32_dpp v2, v2, v2 row_ror:1 row_mask:0xf bank_mask:0xf
    v_permlane32_swap_b32 v6, v8
    v_permlane32_swap_b32 v7, v9
    v_add_f32 v6, v6, v8
    v_add_f32 v7, v7, v9
    s_nop 1
    v_permlane16_swap_b32 v6, v7
    v_add_f32 v6, v6, v7
    s_nop 1
    v_add_f32_dpp v6, v6, v6 row_ror:8 row_mask:0xf bank_mask:0xf
    s_nop 1
    v_add_f32_dpp v6, v6, v6 row_ror:4 row_mask:0xf bank_mask:0xf
    s_nop 1
    v_add_f32_dpp v6, v6, v6 row_ror:2 row_mask:0xf bank_mask:0xf
    s_nop 1
    v_add_f32_dpp v6, v6, v6 row_ror:1 row_mask:0xf bank_mask:0xf
    v_permlane32_swap_b32 v14, v16
    v_permlane32_swap_b32 v15, v17
    v_add_f32 v14, v14, v16
    v_add_f32 v15, v15, v17
    s_nop 1
    v_permlane16_swap_b32 v14, v15
    v_add_f32 v14, v14, v15
    s_nop 1
    v_add_f32_dpp v14, v14, v14 row_ror:8 row_mask:0xf bank_mask:0xf
    s_nop 1
    v_add_f32_dpp v14, v14, v14 row_ror:4 row_mask:0xf bank_mask:0xf
    s_nop 1
    v_add_f32_dpp v14, v14, v14 row_ror:2 row_mask:0xf bank_mask:0xf
    s_nop 1
    v_add_f32_dpp v14, v14, v14 row_ror:1 row_mask:0xf bank_mask:0xf
    v_cvt_pk_bf16_f32 v22, v2, v2
    v_lshlrev_b32 v2, 16, v22
    v_mul_f32 v23, 0xbfb8aa3b, v2
    v_exp_f32 v23, v23
    s_nop 0
    v_add_f32 v23, 1.0, v23
    v_rcp_f32 v23, v23
    s_nop 0
    v_mul_f32 v2, v2, v23
    v_cvt_pk_bf16_f32 v22, v2, v2
    v_lshlrev_b32 v2, 16, v22
    v_cvt_pk_bf16_f32 v22, v6, v6
    v_lshlrev_b32 v6, 16, v22
    v_mul_f32 v23, 0xbfb8aa3b, v6
    v_exp_f32 v23, v23
    s_nop 0
    v_add_f32 v23, 1.0, v23
    v_rcp_f32 v23, v23
    s_nop 0
    v_mul_f32 v6, v6, v23
    v_cvt_pk_bf16_f32 v22, v6, v6
    v_lshlrev_b32 v6, 16, v22
    v_cvt_pk_bf16_f32 v22, v14, v14
    v_lshlrev_b32 v14, 16, v22
    v_mul_f32 v23, 0xbfb8aa3b, v14
    v_exp_f32 v23, v23
    s_nop 0
    v_add_f32 v23, 1.0, v23
    v_rcp_f32 v23, v23
    s_nop 0
    v_mul_f32 v14, v14, v23
    v_cvt_pk_bf16_f32 v22, v14, v14
    v_lshlrev_b32 v14, 16, v22
    v_readlane_b32 s40, v2, 0
    v_readlane_b32 s41, v2, 16
    v_readlane_b32 s42, v2, 32
    v_readlane_b32 s43, v2, 48
    v_readlane_b32 s44, v6, 0
    v_readlane_b32 s45, v6, 16
    v_readlane_b32 s46, v6, 32
    v_readlane_b32 s47, v6, 48
    v_readlane_b32 s48, v14, 0
    v_readlane_b32 s49, v14, 16
    v_readlane_b32 s50, v14, 32
    v_readlane_b32 s51, v14, 48
    s_pack_hh_b32_b16 s40, s40, s41
    s_pack_hh_b32_b16 s41, s42, s43
    s_pack_hh_b32_b16 s42, s44, s45
    s_pack_hh_b32_b16 s43, s46, s47
    s_pack_hh_b32_b16 s44, s48, s49
    s_pack_hh_b32_b16 s45, s50, s51
    s_lshl_b32 s32, s25, 10
    s_add_u32 s32, s32, 135168
    v_add_u32 v26, s32, v0
    ds_read_b128 v[6:9], v26 offset:0
    ds_read_b128 v[10:13], v26 offset:4096
    ds_read_b128 v[14:17], v26 offset:8192
    v_mov_b32 v2, 0
    v_mov_b32 v3, 0
    s_waitcnt lgkmcnt(0)
    v_dot2c_f32_bf16 v2, s40, v6
    v_dot2c_f32_bf16 v3, s40, v7
    v_dot2c_f32_bf16 v2, s41, v8
    v_dot2c_f32_bf16 v3, s41, v9
    v_dot2c_f32_bf16 v2, s42, v10
    v_dot2c_f32_bf16 v3, s42, v11
    v_dot2c_f32_bf16 v2, s43, v12
    v_dot2c_f32_bf16 v3, s43, v13
    v_dot2c_f32_bf16 v2, s44, v14
    v_dot2c_f32_bf16 v3, s44, v15
    v_dot2c_f32_bf16 v2, s45, v16
    v_dot2c_f32_bf16 v3, s45, v17
zpub_34:
    s_nop 3
    v_mov_b32_dpp v4, v2 quad_perm:[1,1,3,3] row_mask:0xf bank_mask:0xf
    v_mov_b32_dpp v5, v3 quad_perm:[1,1,3,3] row_mask:0xf bank_mask:0xf
    v_lshrrev_b32 v26, 4, v27
    v_lshlrev_b32 v26, 11, v26
    v_bfe_u32 v25, v27, 1, 3
    v_lshl_add_u32 v26, v25, 4, v26
    v_and_b32 v25, 1, v27
    s_lshl_b32 s32, s96, 15
    s_lshl_b32 s33, s25, 13
    s_add_u32 s32, s32, s33
    s_lshl_b32 s33, s97, 7
    s_add_u32 s32, s32, s33
    s_add_u32 s32, s32, s28
    s_add_u32 s32, s32, 212992
    v_cmp_eq_u32 vcc, 0, v25
    s_and_saveexec_b64 s[36:37], vcc
    buffer_store_dwordx4 v[2:5], v26, s[12:15], s32 offen
    s_mov_b64 exec, -1
    s_cmp_eq_u32 s55, 0
    s_cbranch_scc1 na2_33
    s_lshl_b32 s32, s21, 11
    s_add_u32 s32, s32, s28
    s_add_u32 s32, s32, 212992
poll_35:
    s_nop 3
    buffer_load_dwordx4 v[4:7], v0, s[12:15], s32 offen sc1
    buffer_load_dwordx4 v[8:11], v0, s[12:15], s32 offen offset:1024 sc1
    s_waitcnt vmcnt(0)
    v_max3_u32 v24, v4, v5, v6
    v_max3_u32 v24, v24, v7, v8
    v_max3_u32 v24, v24, v9, v10
    v_max_u32 v24, v24, v11
    v_cmp_eq_u32 vcc, -1, v24
    s_cbranch_vccz polld_36
    s_sleep 1
    s_sub_u32 s31, s31, 1
    s_cbranch_scc0 poll_35
    s_branch main_bail
polld_36:
    s_nop 3
    v_add_f32 v4, v4, v8
    v_add_f32 v5, v5, v9
    v_add_f32 v6, v6, v10
    v_add_f32 v7, v7, v11
    v_mov_b32 v8, v4
    s_nop 1
    v_permlane32_swap_b32 v4, v8
    v_add_f32 v4, v4, v8
    v_mov_b32 v8, v5
    s_nop 1
    v_permlane32_swap_b32 v5, v8
    v_add_f32 v5, v5, v8
    v_mov_b32 v8, v6
    s_nop 1
    v_permlane32_swap_b32 v6, v8
    v_add_f32 v6, v6, v8
    v_mov_b32 v8, v7
    s_nop 1
    v_permlane32_swap_b32 v7, v8
    v_add_f32 v7, v7, v8
    v_mov_b32 v8, v4
    s_nop 1
    v_permlane16_swap_b32 v4, v8
    v_add_f32 v4, v4, v8
    v_mov_b32 v8, v5
    s_nop 1
    v_permlane16_swap_b32 v5, v8
    v_add_f32 v5, v5, v8
    v_mov_b32 v8, v6
    s_nop 1
    v_permlane16_swap_b32 v6, v8
    v_add_f32 v6, v6, v8
    v_mov_b32 v8, v7
    s_nop 1
    v_permlane16_swap_b32 v7, v8
    v_add_f32 v7, v7, v8
    v_add_f32_dpp v4, v4, v4 row_ror:8 row_mask:0xf bank_mask:0xf
    v_add_f32_dpp v5, v5, v5 row_ror:8 row_mask:0xf bank_mask:0xf
    v_add_f32_dpp v6, v6, v6 row_ror:8 row_mask:0xf bank_mask:0xf
    v_add_f32_dpp v7, v7, v7 row_ror:8 row_mask:0xf bank_mask:0xf
    v_lshrrev_b32 v26, 3, v27
    v_lshlrev_b32 v26, 14, v26
    v_and_b32 v25, 7, v27
    v_lshl_add_u32 v26, v25, 4, v26
    s_lshl_b32 s32, s97, 10
    s_lshl_b32 s33, s96, 7
    s_add_u32 s32, s32, s33
    s_add_u32 s32, s32, s28
    s_add_u32 s32, s32, 475136
    buffer_store_dwordx4 v[4:7], v26, s[12:15], s32 offen sc1
    v_and_b32 v26, 7, v27
    s_lshl_b32 s32, s26, 7
    s_add_u32 s32, s32, 162304
    v_lshlrev_b32 v25, 4, v26
    v_add_u32 v25, s32, v25
    ds_read_b128 v[10:13], v25
    s_lshl_b32 s32, s21, 10
    s_add_u32 s32, s32, s28
    s_add_u32 s32, s32, 475136
poll_37:
    s_nop 3
    buffer_load_dwordx4 v[4:7], v0, s[12:15], s32 offen sc1
    s_waitcnt vmcnt(0)
    v_max3_u32 v24, v4, v5, v6
    v_max_u32 v24, v24, v7
    v_cmp_eq_u32 vcc, -1, v24
    s_cbranch_vccz polld_38
    s_sleep 1
    s_sub_u32 s31, s31, 1
    s_cbranch_scc0 poll_37
    s_branch main_bail
polld_38:
    s_nop 3
    s_waitcnt lgkmcnt(0)
    v_mov_b32 v8, v4
    s_nop 1
    v_permlane32_swap_b32 v4, v8
    v_add_f32 v4, v4, v8
    v_mov_b32 v8, v5
    s_nop 1
    v_permlane32_swap_b32 v5, v8
    v_add_f32 v5, v5, v8
    v_mov_b32 v8, v6
    s_nop 1
    v_permlane32_swap_b32 v6, v8
    v_add_f32 v6, v6, v8
    v_mov_b32 v8, v7
    s_nop 1
    v_permlane32_swap_b32 v7, v8
    v_add_f32 v7, v7, v8
    v_mov_b32 v8, v4
    s_nop 1
    v_permlane16_swap_b32 v4, v8
    v_add_f32 v4, v4, v8
    v_mov_b32 v8, v5
    s_nop 1
    v_permlane16_swap_b32 v5, v8
    v_add_f32 v5, v5, v8
    v_mov_b32 v8, v6
    s_nop 1
    v_permlane16_swap_b32 v6, v8
    v_add_f32 v6, v6, v8
    v_mov_b32 v8, v7
    s_nop 1
    v_permlane16_swap_b32 v7, v8
    v_add_f32 v7, v7, v8
    v_add_f32_dpp v4, v4, v4 row_ror:8 row_mask:0xf bank_mask:0xf
    v_add_f32_dpp v5, v5, v5 row_ror:8 row_mask:0xf bank_mask:0xf
    v_add_f32_dpp v6, v6, v6 row_ror:8 row_mask:0xf bank_mask:0xf
    v_add_f32_dpp v7, v7, v7 row_ror:8 row_mask:0xf bank_mask:0xf
    v_cvt_pk_bf16_f32 v8, v4, v5
    v_lshlrev_b32 v4, 16, v8
    v_and_b32 v5, 0xffff0000, v8
    v_cvt_pk_bf16_f32 v8, v6, v7
    v_lshlrev_b32 v6, 16, v8
    v_and_b32 v7, 0xffff0000, v8
    v_add_f32 v10, v10, v4
    v_add_f32 v11, v11, v5
    v_add_f32 v12, v12, v6
    v_add_f32 v13, v13, v7
    v_cvt_pk_bf16_f32 v14, v10, v11
    v_cvt_pk_bf16_f32 v15, v12, v13
    v_lshlrev_b32 v10, 16, v14
    v_and_b32 v11, 0xffff0000, v14
    v_lshlrev_b32 v12, 16, v15
    v_and_b32 v13, 0xffff0000, v15
    s_cmp_eq_u32 s26, 1
    s_cbranch_scc1 outw_39
    v_lshlrev_b32 v24, 3, v26
    s_lshl_b32 s32, s96, 10
    s_lshl_b32 s33, s97, 6
    s_add_u32 s32, s32, s33
    s_add_u32 s32, s32, s28
    s_add_u32 s32, s32, 606208
    s_mov_b64 exec, 0xff
    buffer_store_dwordx2 v[14:15], v24, s[12:15], s32 offen
    s_mov_b64 exec, -1
    v_lshlrev_b32 v25, 4, v26
    v_add_u32 v25, 156672, v25
    ds_write_b128 v25, v[10:13]
    s_waitcnt lgkmcnt(0)
    s_branch na2_33
outw_39:
    s_nop 3
    s_cmp_lg_u32 s96, 0
    s_cbranch_scc1 na2_33
    v_lshlrev_b32 v25, 3, v26
    s_lshl_b32 s32, s27, 1
    s_add_u32 s32, s32, s20
    s_sub_u32 s32, s32, 2
    s_lshl_b32 s32, s32, 10
    s_lshl_b32 s33, s97, 6
    s_add_u32 s32, s32, s33
    s_mov_b64 exec, 0xff
    buffer_store_dwordx2 v[14:15], v25, s[56:59], s32 offen
    s_mov_b64 exec, -1
na2_33:
    s_nop 3
    s_cmp_eq_u32 s27, 4
    s_cbranch_scc1 main_end
    s_cmp_lg_u32 s24, 0
    s_cbranch_scc1 nos3a_40
    s_lshl_b32 s32, s96, 10
    s_add_u32 s32, s32, s29
    s_add_u32 s32, s32, 606208
poll_41:
    s_nop 3
    buffer_load_dwordx4 v[2:5], v0, s[12:15], s32 offen sc1
    s_waitcnt vmcnt(0)
    v_max3_u32 v24, v2, v3, v4
    v_max_u32 v24, v24, v5
    v_cmp_eq_u32 vcc, -1, v24
    s_cbranch_vccz polld_42
    s_sleep 1
    s_sub_u32 s31, s31, 1
    s_cbranch_scc0 poll_41
    s_branch main_bail
polld_42:
    s_nop 3
    v_lshlrev_b32 v10, 16, v2
    v_and_b32 v11, 0xffff0000, v2
    v_lshlrev_b32 v12, 16, v3
    v_and_b32 v13, 0xffff0000, v3
    v_lshlrev_b32 v14, 16, v4
    v_and_b32 v15, 0xffff0000, v4
    v_lshlrev_b32 v16, 16, v5
    v_and_b32 v17, 0xffff0000, v5
    v_add_f32 v22, v10, v11
    v_add_f32 v22, v22, v12
    v_add_f32 v22, v22, v13
    v_add_f32 v22, v22, v14
    v_add_f32 v22, v22, v15
    v_add_f32 v22, v22, v16
    v_add_f32 v22, v22, v17
    s_nop 1
    v_add_f32_dpp v22, v22, v22 row_ror:8 row_mask:0xf bank_mask:0xf
    s_nop 1
    v_add_f32_dpp v22, v22, v22 row_ror:4 row_mask:0xf bank_mask:0xf
    s_nop 1
    v_add_f32_dpp v22, v22, v22 row_ror:2 row_mask:0xf bank_mask:0xf
    s_nop 1
    v_add_f32_dpp v22, v22, v22 row_ror:1 row_mask:0xf bank_mask:0xf
    v_mov_b32 v23, v22
    s_nop 1
    v_permlane16_swap_b32 v22, v23
    v_add_f32 v22, v22, v23
    v_mov_b32 v23, v22
    s_nop 1
    v_permlane32_swap_b32 v22, v23
    v_add_f32 v22, v22, v23
    v_mul_f32 v22, 0x3b000000, v22
    v_sub_f32 v24, v10, v22
    v_mul_f32 v23, v24, v24
    v_sub_f32 v24, v11, v22
    v_fma_f32 v23, v24, v24, v23
    v_sub_f32 v24, v12, v22
    v_fma_f32 v23, v24, v24, v23
    v_sub_f32 v24, v13, v22
    v_fma_f32 v23, v24, v24, v23
    v_sub_f32 v24, v14, v22
    v_fma_f32 v23, v24, v24, v23
    v_sub_f32 v24, v15, v22
    v_fma_f32 v23, v24, v24, v23
    v_sub_f32 v24, v16, v22
    v_fma_f32 v23, v24, v24, v23
    v_sub_f32 v24, v17, v22
    v_fma_f32 v23, v24, v24, v23
    s_nop 1
    v_add_f32_dpp v23, v23, v23 row_ror:8 row_mask:0xf bank_mask:0xf
    s_nop 1
    v_add_f32_dpp v23, v23, v23 row_ror:4 row_mask:0xf bank_mask:0xf
    s_nop 1
    v_add_f32_dpp v23, v23, v23 row_ror:2 row_mask:0xf bank_mask:0xf
    s_nop 1
    v_add_f32_dpp v23, v23, v23 row_ror:1 row_mask:0xf bank_mask:0xf
    v_mov_b32 v24, v23
    s_nop 1
    v_permlane16_swap_b32 v23, v24
    v_add_f32 v23, v23, v24
    v_mov_b32 v24, v23
    s_nop 1
    v_permlane32_swap_b32 v23, v24
    v_add_f32 v23, v23, v24
    v_mul_f32 v23, 0x3b000000, v23
    v_cvt_pk_bf16_f32 v24, v22, v23
    v_lshlrev_b32 v22, 16, v24
    v_and_b32 v23, 0xffff0000, v24
    v_add_f32 v23, 0x3727c5ac, v23
    v_cvt_pk_bf16_f32 v24, v23, v23
    v_lshlrev_b32 v23, 16, v24
    v_sqrt_f32 v23, v23
    s_nop 0
    v_cvt_pk_bf16_f32 v24, v23, v23
    v_lshlrev_b32 v23, 16, v24
    v_rcp_f32 v23, v23
    v_sub_f32 v10, v10, v22
    v_sub_f32 v11, v11, v22
    v_cvt_pk_bf16_f32 v24, v10, v11
    v_lshlrev_b32 v10, 16, v24
    v_and_b32 v11, 0xffff0000, v24
    v_mul_f32 v10, v10, v23
    v_mul_f32 v11, v11, v23
    v_cvt_pk_bf16_f32 v18, v10, v11
    v_sub_f32 v12, v12, v22
    v_sub_f32 v13, v13, v22
    v_cvt_pk_bf16_f32 v24, v12, v13
    v_lshlrev_b32 v12, 16, v24
    v_and_b32 v13, 0xffff0000, v24
    v_mul_f32 v12, v12, v23
    v_mul_f32 v13, v13, v23
    v_cvt_pk_bf16_f32 v19, v12, v13
    v_sub_f32 v14, v14, v22
    v_sub_f32 v15, v15, v22
    v_cvt_pk_bf16_f32 v24, v14, v15
    v_lshlrev_b32 v14, 16, v24
    v_and_b32 v15, 0xffff0000, v24
    v_mul_f32 v14, v14, v23
    v_mul_f32 v15, v15, v23
    v_cvt_pk_bf16_f32 v20, v14, v15
    v_sub_f32 v16, v16, v22
    v_sub_f32 v17, v17, v22
    v_cvt_pk_bf16_f32 v24, v16, v17
    v_lshlrev_b32 v16, 16, v24
    v_and_b32 v17, 0xffff0000, v24
    v_mul_f32 v16, v16, v23
    v_mul_f32 v17, v17, v23
    v_cvt_pk_bf16_f32 v21, v16, v17
    v_add_u32 v26, 158976, v0
    ds_write_b128 v26, v[18:21]
    s_waitcnt lgkmcnt(0)
nos3a_40:
    s_nop 3
    s_barrier
    v_add_u32 v26, 158976, v0
    ds_read_b128 v[10:13], v26
    s_lshl_b32 s32, s24, 10
    s_add_u32 s32, s32, 90112
    v_add_u32 v26, s32, v0
    ds_read_b128 v[14:17], v26 offset:0
    ds_read_b128 v[18:21], v26 offset:8192
    s_waitcnt lgkmcnt(0)
    v_dot2_f32_bf16 v2, v14, v10, 0
    v_dot2_f32_bf16 v3, v15, v10, 0
    v_dot2_f32_bf16 v4, v16, v10, 0
    v_dot2_f32_bf16 v5, v17, v10, 0
    v_dot2_f32_bf16 v2, v18, v11, v2
    v_dot2_f32_bf16 v3, v19, v11, v3
    v_dot2_f32_bf16 v4, v20, v11, v4
    v_dot2_f32_bf16 v5, v21, v11, v5
    ds_read_b128 v[14:17], v26 offset:16384
    ds_read_b128 v[18:21], v26 offset:24576
    s_waitcnt lgkmcnt(0)
    v_dot2_f32_bf16 v2, v14, v12, v2
    v_dot2_f32_bf16 v3, v15, v12, v3
    v_dot2_f32_bf16 v4, v16, v12, v4
    v_dot2_f32_bf16 v5, v17, v12, v5
    v_dot2_f32_bf16 v2, v18, v13, v2
    v_dot2_f32_bf16 v3, v19, v13, v3
    v_dot2_f32_bf16 v4, v20, v13, v4
    v_dot2_f32_bf16 v5, v21, v13, v5
    s_nop 1
    v_permlane32_swap_b32 v2, v4
    v_permlane32_swap_b32 v3, v5
    v_add_f32 v2, v2, v4
    v_add_f32 v3, v3, v5
    s_nop 1
    v_permlane16_swap_b32 v2, v3
    v_add_f32 v2, v2, v3
    s_nop 1
    v_add_f32_dpp v2, v2, v2 row_ror:8 row_mask:0xf bank_mask:0xf
    s_nop 1
    v_add_f32_dpp v2, v2, v2 row_ror:4 row_mask:0xf bank_mask:0xf
    s_nop 1
    v_add_f32_dpp v2, v2, v2 row_ror:2 row_mask:0xf bank_mask:0xf
    s_nop 1
    v_add_f32_dpp v2, v2, v2 row_ror:1 row_mask:0xf bank_mask:0xf
    v_cvt_pk_bf16_f32 v6, v2, v2
    v_lshlrev_b32 v2, 16, v6
    s_nop 0
    v_readlane_b32 s40, v2, 0
    v_readlane_b32 s41, v2, 16
    v_readlane_b32 s42, v2, 32
    v_readlane_b32 s43, v2, 48
    s_pack_hh_b32_b16 s40, s40, s41
    s_pack_hh_b32_b16 s41, s42, s43
    v_mov_b32 v2, s40
    v_mov_b32 v3, s41
    v_mov_b32 v4, 0
    s_lshl_b32 s32, s21, 6
    s_lshl_b32 s33, s24, 3
    s_add_u32 s32, s32, s33
    s_add_u32 s32, s32, s29
    s_add_u32 s32, s32, 614400
    s_mov_b64 exec, 1
    buffer_store_dwordx2 v[2:3], v4, s[12:15], s32 offen
    s_mov_b64 exec, -1
    v_and_b32 v6, 0xf0, v0
    s_cmp_lg_u32 s24, 0
    s_cbranch_scc1 noq2_43
    s_lshl_b32 s32, s22, 8
    s_add_u32 s32, s32, s29
    s_add_u32 s32, s32, 614400
poll_44:
    s_nop 3
    buffer_load_dwordx4 v[2:5], v6, s[12:15], s32 offen sc1
    s_waitcnt vmcnt(0)
    v_max3_u32 v24, v2, v3, v4
    v_max_u32 v24, v24, v5
    v_cmp_eq_u32 vcc, -1, v24
    s_cbranch_vccz polld_45
    s_sleep 1
    s_sub_u32 s31, s31, 1
    s_cbranch_scc0 poll_44
    s_branch main_bail
polld_45:
    s_nop 3
    v_add_u32 v7, 161024, v6
    ds_write_b128 v7, v[2:5]
    s_waitcnt lgkmcnt(0)
noq2_43:
    s_nop 3
    s_barrier
    v_add_u32 v7, 161024, v6
    ds_read_b128 v[2:5], v7
    s_waitcnt lgkmcnt(0)
    s_add_u32 s30, s30, 67108864
    v_mov_b32 v6, 0
    v_mov_b32 v7, 0
    v_mov_b32 v8, 0
    v_mov_b32 v9, 0
    v_mov_b32 v10, 0
    v_mov_b32 v11, 0
    v_mov_b32 v12, 0
    v_mov_b32 v13, 0
    v_mov_b32 v14, 0xff7fffff
    v_mov_b32 v15, 0
    v_dot2_f32_bf16 v16, v28, v2, 0
    v_dot2_f32_bf16 v17, v32, v2, 0
    v_dot2_f32_bf16 v18, v36, v2, 0
    v_dot2_f32_bf16 v19, v40, v2, 0
    v_dot2_f32_bf16 v20, v44, v2, 0
    v_dot2_f32_bf16 v21, v48, v2, 0
    v_dot2_f32_bf16 v22, v52, v2, 0
    v_dot2_f32_bf16 v23, v56, v2, 0
    v_dot2_f32_bf16 v16, v29, v3, v16
    v_dot2_f32_bf16 v17, v33, v3, v17
    v_dot2_f32_bf16 v18, v37, v3, v18
    v_dot2_f32_bf16 v19, v41, v3, v19
    v_dot2_f32_bf16 v20, v45, v3, v20
    v_dot2_f32_bf16 v21, v49, v3, v21
    v_dot2_f32_bf16 v22, v53, v3, v22
    v_dot2_f32_bf16 v23, v57, v3, v23
    v_dot2_f32_bf16 v16, v30, v4, v16
    v_dot2_f32_bf16 v17, v34, v4, v17
    v_dot2_f32_bf16 v18, v38, v4, v18
    v_dot2_f32_bf16 v19, v42, v4, v19
    v_dot2_f32_bf16 v20, v46, v4, v20
    v_dot2_f32_bf16 v21, v50, v4, v21
    v_dot2_f32_bf16 v22, v54, v4, v22
    v_dot2_f32_bf16 v23, v58, v4, v23
    v_dot2_f32_bf16 v16, v31, v5, v16
    v_dot2_f32_bf16 v17, v35, v5, v17
    v_dot2_f32_bf16 v18, v39, v5, v18
    v_dot2_f32_bf16 v19, v43, v5, v19
    v_dot2_f32_bf16 v20, v47, v5, v20
    v_dot2_f32_bf16 v21, v51, v5, v21
    v_dot2_f32_bf16 v22, v55, v5, v22
    v_dot2_f32_bf16 v23, v59, v5, v23
    s_cmp_eq_u32 s27, 3
    s_cbranch_scc1 norefk_46
    s_add_u32 s34, s30, 0
    buffer_load_dwordx4 v[28:31], v0, s[4:7], s34 offen offset:0 nt
    buffer_load_dwordx4 v[32:35], v0, s[4:7], s34 offen offset:1024 nt
    buffer_load_dwordx4 v[36:39], v0, s[4:7], s34 offen offset:2048 nt
    buffer_load_dwordx4 v[40:43], v0, s[4:7], s34 offen offset:3072 nt
    s_add_u32 s34, s30, 4096
    buffer_load_dwordx4 v[44:47], v0, s[4:7], s34 offen offset:0 nt
    buffer_load_dwordx4 v[48:51], v0, s[4:7], s34 offen offset:1024 nt
    buffer_load_dwordx4 v[52:55], v0, s[4:7], s34 offen offset:2048 nt
    buffer_load_dwordx4 v[56:59], v0, s[4:7], s34 offen offset:3072 nt
norefk_46:
    s_nop 3
    v_add_f32_dpp v16, v16, v16 row_mirror row_mask:0xf bank_mask:0x3
    v_add_f32_dpp v16, v20, v20 row_mirror row_mask:0xf bank_mask:0xc
    v_add_f32_dpp v17, v17, v17 row_mirror row_mask:0xf bank_mask:0x3
    v_add_f32_dpp v17, v21, v21 row_mirror row_mask:0xf bank_mask:0xc
    v_add_f32_dpp v18, v18, v18 row_mirror row_mask:0xf bank_mask:0x3
    v_add_f32_dpp v18, v22, v22 row_mirror row_mask:0xf bank_mask:0xc
    v_add_f32_dpp v19, v19, v19 row_mirror row_mask:0xf bank_mask:0x3
    v_add_f32_dpp v19, v23, v23 row_mirror row_mask:0xf bank_mask:0xc
    v_add_f32_dpp v16, v16, v16 row_half_mirror row_mask:0xf bank_mask:0x5
    v_add_f32_dpp v16, v18, v18 row_half_mirror row_mask:0xf bank_mask:0xa
    v_add_f32_dpp v17, v17, v17 row_half_mirror row_mask:0xf bank_mask:0x5
    v_add_f32_dpp v17, v19, v19 row_half_mirror row_mask:0xf bank_mask:0xa
    v_add_f32_dpp v16, v16, v16 quad_perm:[2,3,0,1] row_mask:0xf bank_mask:0xf
    s_nop 0
    v_add_f32_dpp v17, v17, v17 quad_perm:[2,3,0,1] row_mask:0xf bank_mask:0xf
    v_add_f32_dpp v16, v16, v16 quad_perm:[1,0,3,2] row_mask:0xf bank_mask:0xf
    s_nop 0
    v_add_f32_dpp v17, v17, v17 quad_perm:[1,0,3,2] row_mask:0xf bank_mask:0xf
    v_cvt_pk_bf16_f32 v18, v16, v17
    v_lshlrev_b32 v16, 16, v18
    v_and_b32 v17, 0xffff0000, v18
    v_mul_f32 v16, 0x3db504f3, v16
    v_mul_f32 v17, 0x3db504f3, v17
    v_cvt_pk_bf16_f32 v18, v16, v17
    v_lshlrev_b32 v16, 16, v18
    v_and_b32 v17, 0xffff0000, v18
    v_max_f32 v18, v16, v17
    s_nop 1
    v_max_f32_dpp v18, v18, v18 row_half_mirror row_mask:0xf bank_mask:0xf
    s_nop 1
    v_max_f32_dpp v18, v18, v18 row_mirror row_mask:0xf bank_mask:0xf
    v_max_f32 v18, v18, v14
    v_sub_f32 v19, v14, v18
    v_sub_f32 v16, v16, v18
    v_sub_f32 v17, v17, v18
    v_mul_f32 v19, 0x3fb8aa3b, v19
    v_mul_f32 v16, 0x3fb8aa3b, v16
    v_mul_f32 v17, 0x3fb8aa3b, v17
    v_exp_f32 v19, v19
    v_exp_f32 v16, v16
    v_exp_f32 v17, v17
    v_mov_b32 v14, v18
    v_cvt_pk_bf16_f32 v24, v16, 0
    v_cvt_pk_bf16_f32 v25, v17, 0
    v_fma_f32 v15, v15, v19, v16
    v_lshlrev_b32 v26, 16, v24
    v_lshlrev_b32 v27, 16, v25
    v_add_f32 v15, v15, v17
    v_mul_f32 v6, v6, v19
    v_mul_f32 v7, v7, v19
    v_mul_f32 v8, v8, v19
    v_mul_f32 v9, v9, v19
    v_mul_f32 v10, v10, v19
    v_mul_f32 v11, v11, v19
    v_mul_f32 v12, v12, v19
    v_mul_f32 v13, v13, v19
    v_dot2c_f32_bf16_dpp v6, v24, v156 row_newbcast:0 row_mask:0xf bank_mask:0xf
    v_dot2c_f32_bf16_dpp v7, v26, v156 row_newbcast:0 row_mask:0xf bank_mask:0xf
    v_dot2c_f32_bf16_dpp v8, v24, v157 row_newbcast:0 row_mask:0xf bank_mask:0xf
    v_dot2c_f32_bf16_dpp v9, v26, v157 row_newbcast:0 row_mask:0xf bank_mask:0xf
    v_dot2c_f32_bf16_dpp v10, v24, v158 row_newbcast:0 row_mask:0xf bank_mask:0xf
    v_dot2c_f32_bf16_dpp v11, v26, v158 row_newbcast:0 row_mask:0xf bank_mask:0xf
    v_dot2c_f32_bf16_dpp v12, v24, v159 row_newbcast:0 row_mask:0xf bank_mask:0xf
    v_dot2c_f32_bf16_dpp v13, v26, v159 row_newbcast:0 row_mask:0xf bank_mask:0xf
    v_dot2c_f32_bf16_dpp v6, v25, v160 row_newbcast:0 row_mask:0xf bank_mask:0xf
    v_dot2c_f32_bf16_dpp v7, v27, v160 row_newbcast:0 row_mask:0xf bank_mask:0xf
    v_dot2c_f32_bf16_dpp v8, v25, v161 row_newbcast:0 row_mask:0xf bank_mask:0xf
    v_dot2c_f32_bf16_dpp v9, v27, v161 row_newbcast:0 row_mask:0xf bank_mask:0xf
    v_dot2c_f32_bf16_dpp v10, v25, v162 row_newbcast:0 row_mask:0xf bank_mask:0xf
    v_dot2c_f32_bf16_dpp v11, v27, v162 row_newbcast:0 row_mask:0xf bank_mask:0xf
    v_dot2c_f32_bf16_dpp v12, v25, v163 row_newbcast:0 row_mask:0xf bank_mask:0xf
    v_dot2c_f32_bf16_dpp v13, v27, v163 row_newbcast:0 row_mask:0xf bank_mask:0xf
    v_dot2c_f32_bf16_dpp v6, v24, v164 row_newbcast:4 row_mask:0xf bank_mask:0xf
    v_dot2c_f32_bf16_dpp v7, v26, v164 row_newbcast:4 row_mask:0xf bank_mask:0xf
    v_dot2c_f32_bf16_dpp v8, v24, v165 row_newbcast:4 row_mask:0xf bank_mask:0xf
    v_dot2c_f32_bf16_dpp v9, v26, v165 row_newbcast:4 row_mask:0xf bank_mask:0xf
    v_dot2c_f32_bf16_dpp v10, v24, v166 row_newbcast:4 row_mask:0xf bank_mask:0xf
    v_dot2c_f32_bf16_dpp v11, v26, v166 row_newbcast:4 row_mask:0xf bank_mask:0xf
    v_dot2c_f32_bf16_dpp v12, v24, v167 row_newbcast:4 row_mask:0xf bank_mask:0xf
    v_dot2c_f32_bf16_dpp v13, v26, v167 row_newbcast:4 row_mask:0xf bank_mask:0xf
    v_dot2c_f32_bf16_dpp v6, v25, v168 row_newbcast:4 row_mask:0xf bank_mask:0xf
    v_dot2c_f32_bf16_dpp v7, v27, v168 row_newbcast:4 row_mask:0xf bank_mask:0xf
    v_dot2c_f32_bf16_dpp v8, v25, v169 row_newbcast:4 row_mask:0xf bank_mask:0xf
    v_dot2c_f32_bf16_dpp v9, v27, v169 row_newbcast:4 row_mask:0xf bank_mask:0xf
    v_dot2c_f32_bf16_dpp v10, v25, v170 row_newbcast:4 row_mask:0xf bank_mask:0xf
    v_dot2c_f32_bf16_dpp v11, v27, v170 row_newbcast:4 row_mask:0xf bank_mask:0xf
    v_dot2c_f32_bf16_dpp v12, v25, v171 row_newbcast:4 row_mask:0xf bank_mask:0xf
    v_dot2c_f32_bf16_dpp v13, v27, v171 row_newbcast:4 row_mask:0xf bank_mask:0xf
    v_dot2c_f32_bf16_dpp v6, v24, v172 row_newbcast:8 row_mask:0xf bank_mask:0xf
    v_dot2c_f32_bf16_dpp v7, v26, v172 row_newbcast:8 row_mask:0xf bank_mask:0xf
    v_dot2c_f32_bf16_dpp v8, v24, v173 row_newbcast:8 row_mask:0xf bank_mask:0xf
    v_dot2c_f32_bf16_dpp v9, v26, v173 row_newbcast:8 row_mask:0xf bank_mask:0xf
    v_dot2c_f32_bf16_dpp v10, v24, v174 row_newbcast:8 row_mask:0xf bank_mask:0xf
    v_dot2c_f32_bf16_dpp v11, v26, v174 row_newbcast:8 row_mask:0xf bank_mask:0xf
    v_dot2c_f32_bf16_dpp v12, v24, v175 row_newbcast:8 row_mask:0xf bank_mask:0xf
    v_dot2c_f32_bf16_dpp v13, v26, v175 row_newbcast:8 row_mask:0xf bank_mask:0xf
    v_dot2c_f32_bf16_dpp v6, v25, v176 row_newbcast:8 row_mask:0xf bank_mask:0xf
    v_dot2c_f32_bf16_dpp v7, v27, v176 row_newbcast:8 row_mask:0xf bank_mask:0xf
    v_dot2c_f32_bf16_dpp v8, v25, v177 row_newbcast:8 row_mask:0xf bank_mask:0xf
    v_dot2c_f32_bf16_dpp v9, v27, v177 row_newbcast:8 row_mask:0xf bank_mask:0xf
    v_dot2c_f32_bf16_dpp v10, v25, v178 row_newbcast:8 row_mask:0xf bank_mask:0xf
    v_dot2c_f32_bf16_dpp v11, v27, v178 row_newbcast:8 row_mask:0xf bank_mask:0xf
    v_dot2c_f32_bf16_dpp v12, v25, v179 row_newbcast:8 row_mask:0xf bank_mask:0xf
    v_dot2c_f32_bf16_dpp v13, v27, v179 row_newbcast:8 row_mask:0xf bank_mask:0xf
    v_dot2c_f32_bf16_dpp v6, v24, v180 row_newbcast:12 row_mask:0xf bank_mask:0xf
    v_dot2c_f32_bf16_dpp v7, v26, v180 row_newbcast:12 row_mask:0xf bank_mask:0xf
    v_dot2c_f32_bf16_dpp v8, v24, v181 row_newbcast:12 row_mask:0xf bank_mask:0xf
    v_dot2c_f32_bf16_dpp v9, v26, v181 row_newbcast:12 row_mask:0xf bank_mask:0xf
    v_dot2c_f32_bf16_dpp v10, v24, v182 row_newbcast:12 row_mask:0xf bank_mask:0xf
    v_dot2c_f32_bf16_dpp v11, v26, v182 row_newbcast:12 row_mask:0xf bank_mask:0xf
    v_dot2c_f32_bf16_dpp v12, v24, v183 row_newbcast:12 row_mask:0xf bank_mask:0xf
    v_dot2c_f32_bf16_dpp v13, v26, v183 row_newbcast:12 row_mask:0xf bank_mask:0xf
    v_dot2c_f32_bf16_dpp v6, v25, v184 row_newbcast:12 row_mask:0xf bank_mask:0xf
    v_dot2c_f32_bf16_dpp v7, v27, v184 row_newbcast:12 row_mask:0xf bank_mask:0xf
    v_dot2c_f32_bf16_dpp v8, v25, v185 row_newbcast:12 row_mask:0xf bank_mask:0xf
    v_dot2c_f32_bf16_dpp v9, v27, v185 row_newbcast:12 row_mask:0xf bank_mask:0xf
    v_dot2c_f32_bf16_dpp v10, v25, v186 row_newbcast:12 row_mask:0xf bank_mask:0xf
    v_dot2c_f32_bf16_dpp v11, v27, v186 row_newbcast:12 row_mask:0xf bank_mask:0xf
    v_dot2c_f32_bf16_dpp v12, v25, v187 row_newbcast:12 row_mask:0xf bank_mask:0xf
    v_dot2c_f32_bf16_dpp v13, v27, v187 row_newbcast:12 row_mask:0xf bank_mask:0xf
    s_cmp_eq_u32 s27, 3
    s_cbranch_scc1 norefv_47
    s_add_u32 s34, s30, 0
    buffer_load_dwordx4 v[156:159], v0, s[8:11], s34 offen offset:0 nt
    buffer_load_dwordx4 v[160:163], v0, s[8:11], s34 offen offset:1024 nt
    buffer_load_dwordx4 v[164:167], v0, s[8:11], s34 offen offset:2048 nt
    buffer_load_dwordx4 v[168:171], v0, s[8:11], s34 offen offset:3072 nt
    s_add_u32 s34, s30, 4096
    buffer_load_dwordx4 v[172:175], v0, s[8:11], s34 offen offset:0 nt
    buffer_load_dwordx4 v[176:179], v0, s[8:11], s34 offen offset:1024 nt
    buffer_load_dwordx4 v[180:183], v0, s[8:11], s34 offen offset:2048 nt
    buffer_load_dwordx4 v[184:187], v0, s[8:11], s34 offen offset:3072 nt
norefv_47:
    s_nop 3
    v_dot2_f32_bf16 v16, v60, v2, 0
    v_dot2_f32_bf16 v17, v64, v2, 0
    v_dot2_f32_bf16 v18, v68, v2, 0
    v_dot2_f32_bf16 v19, v72, v2, 0
    v_dot2_f32_bf16 v20, v76, v2, 0
    v_dot2_f32_bf16 v21, v80, v2, 0
    v_dot2_f32_bf16 v22, v84, v2, 0
    v_dot2_f32_bf16 v23, v88, v2, 0
    v_dot2_f32_bf16 v16, v61, v3, v16
    v_dot2_f32_bf16 v17, v65, v3, v17
    v_dot2_f32_bf16 v18, v69, v3, v18
    v_dot2_f32_bf16 v19, v73, v3, v19
    v_dot2_f32_bf16 v20, v77, v3, v20
    v_dot2_f32_bf16 v21, v81, v3, v21
    v_dot2_f32_bf16 v22, v85, v3, v22
    v_dot2_f32_bf16 v23, v89, v3, v23
    v_dot2_f32_bf16 v16, v62, v4, v16
    v_dot2_f32_bf16 v17, v66, v4, v17
    v_dot2_f32_bf16 v18, v70, v4, v18
    v_dot2_f32_bf16 v19, v74, v4, v19
    v_dot2_f32_bf16 v20, v78, v4, v20
    v_dot2_f32_bf16 v21, v82, v4, v21
    v_dot2_f32_bf16 v22, v86, v4, v22
    v_dot2_f32_bf16 v23, v90, v4, v23
    v_dot2_f32_bf16 v16, v63, v5, v16
    v_dot2_f32_bf16 v17, v67, v5, v17
    v_dot2_f32_bf16 v18, v71, v5, v18
    v_dot2_f32_bf16 v19, v75, v5, v19
    v_dot2_f32_bf16 v20, v79, v5, v20
    v_dot2_f32_bf16 v21, v83, v5, v21
    v_dot2_f32_bf16 v22, v87, v5, v22
    v_dot2_f32_bf16 v23, v91, v5, v23
    s_cmp_eq_u32 s27, 3
    s_cbranch_scc1 norefk_48
    s_add_u32 s34, s30, 8192
    buffer_load_dwordx4 v[60:63], v0, s[4:7], s34 offen offset:0 nt
    buffer_load_dwordx4 v[64:67], v0, s[4:7], s34 offen offset:1024 nt
    buffer_load_dwordx4 v[68:71], v0, s[4:7], s34 offen offset:2048 nt
    buffer_load_dwordx4 v[72:75], v0, s[4:7], s34 offen offset:3072 nt
    s_add_u32 s34, s30, 12288
    buffer_load_dwordx4 v[76:79], v0, s[4:7], s34 offen offset:0 nt
    buffer_load_dwordx4 v[80:83], v0, s[4:7], s34 offen offset:1024 nt
    buffer_load_dwordx4 v[84:87], v0, s[4:7], s34 offen offset:2048 nt
    buffer_load_dwordx4 v[88:91], v0, s[4:7], s34 offen offset:3072 nt
norefk_48:
    s_nop 3
    v_add_f32_dpp v16, v16, v16 row_mirror row_mask:0xf bank_mask:0x3
    v_add_f32_dpp v16, v20, v20 row_mirror row_mask:0xf bank_mask:0xc
    v_add_f32_dpp v17, v17, v17 row_mirror row_mask:0xf bank_mask:0x3
    v_add_f32_dpp v17, v21, v21 row_mirror row_mask:0xf bank_mask:0xc
    v_add_f32_dpp v18, v18, v18 row_mirror row_mask:0xf bank_mask:0x3
    v_add_f32_dpp v18, v22, v22 row_mirror row_mask:0xf bank_mask:0xc
    v_add_f32_dpp v19, v19, v19 row_mirror row_mask:0xf bank_mask:0x3
    v_add_f32_dpp v19, v23, v23 row_mirror row_mask:0xf bank_mask:0xc
    v_add_f32_dpp v16, v16, v16 row_half_mirror row_mask:0xf bank_mask:0x5
    v_add_f32_dpp v16, v18, v18 row_half_mirror row_mask:0xf bank_mask:0xa
    v_add_f32_dpp v17, v17, v17 row_half_mirror row_mask:0xf bank_mask:0x5
    v_add_f32_dpp v17, v19, v19 row_half_mirror row_mask:0xf bank_mask:0xa
    v_add_f32_dpp v16, v16, v16 quad_perm:[2,3,0,1] row_mask:0xf bank_mask:0xf
    s_nop 0
    v_add_f32_dpp v17, v17, v17 quad_perm:[2,3,0,1] row_mask:0xf bank_mask:0xf
    v_add_f32_dpp v16, v16, v16 quad_perm:[1,0,3,2] row_mask:0xf bank_mask:0xf
    s_nop 0
    v_add_f32_dpp v17, v17, v17 quad_perm:[1,0,3,2] row_mask:0xf bank_mask:0xf
    v_cvt_pk_bf16_f32 v18, v16, v17
    v_lshlrev_b32 v16, 16, v18
    v_and_b32 v17, 0xffff0000, v18
    v_mul_f32 v16, 0x3db504f3, v16
    v_mul_f32 v17, 0x3db504f3, v17
    v_cvt_pk_bf16_f32 v18, v16, v17
    v_lshlrev_b32 v16, 16, v18
    v_and_b32 v17, 0xffff0000, v18
    v_max_f32 v18, v16, v17
    s_nop 1
    v_max_f32_dpp v18, v18, v18 row_half_mirror row_mask:0xf bank_mask:0xf
    s_nop 1
    v_max_f32_dpp v18, v18, v18 row_mirror row_mask:0xf bank_mask:0xf
    v_max_f32 v18, v18, v14
    v_sub_f32 v19, v14, v18
    v_sub_f32 v16, v16, v18
    v_sub_f32 v17, v17, v18
    v_mul_f32 v19, 0x3fb8aa3b, v19
    v_mul_f32 v16, 0x3fb8aa3b, v16
    v_mul_f32 v17, 0x3fb8aa3b, v17
    v_exp_f32 v19, v19
    v_exp_f32 v16, v16
    v_exp_f32 v17, v17
    v_mov_b32 v14, v18
    v_cvt_pk_bf16_f32 v24, v16, 0
    v_cvt_pk_bf16_f32 v25, v17, 0
    v_fma_f32 v15, v15, v19, v16
    v_lshlrev_b32 v26, 16, v24
    v_lshlrev_b32 v27, 16, v25
    v_add_f32 v15, v15, v17
    v_mul_f32 v6, v6, v19
    v_mul_f32 v7, v7, v19
    v_mul_f32 v8, v8, v19
    v_mul_f32 v9, v9, v19
    v_mul_f32 v10, v10, v19
    v_mul_f32 v11, v11, v19
    v_mul_f32 v12, v12, v19
    v_mul_f32 v13, v13, v19
    v_dot2c_f32_bf16_dpp v6, v24, v188 row_newbcast:0 row_mask:0xf bank_mask:0xf
    v_dot2c_f32_bf16_dpp v7, v26, v188 row_newbcast:0 row_mask:0xf bank_mask:0xf
    v_dot2c_f32_bf16_dpp v8, v24, v189 row_newbcast:0 row_mask:0xf bank_mask:0xf
    v_dot2c_f32_bf16_dpp v9, v26, v189 row_newbcast:0 row_mask:0xf bank_mask:0xf
    v_dot2c_f32_bf16_dpp v10, v24, v190 row_newbcast:0 row_mask:0xf bank_mask:0xf
    v_dot2c_f32_bf16_dpp v11, v26, v190 row_newbcast:0 row_mask:0xf bank_mask:0xf
    v_dot2c_f32_bf16_dpp v12, v24, v191 row_newbcast:0 row_mask:0xf bank_mask:0xf
    v_dot2c_f32_bf16_dpp v13, v26, v191 row_newbcast:0 row_mask:0xf bank_mask:0xf
    v_dot2c_f32_bf16_dpp v6, v25, v192 row_newbcast:0 row_mask:0xf bank_mask:0xf
    v_dot2c_f32_bf16_dpp v7, v27, v192 row_newbcast:0 row_mask:0xf bank_mask:0xf
    v_dot2c_f32_bf16_dpp v8, v25, v193 row_newbcast:0 row_mask:0xf bank_mask:0xf
    v_dot2c_f32_bf16_dpp v9, v27, v193 row_newbcast:0 row_mask:0xf bank_mask:0xf
    v_dot2c_f32_bf16_dpp v10, v25, v194 row_newbcast:0 row_mask:0xf bank_mask:0xf
    v_dot2c_f32_bf16_dpp v11, v27, v194 row_newbcast:0 row_mask:0xf bank_mask:0xf
    v_dot2c_f32_bf16_dpp v12, v25, v195 row_newbcast:0 row_mask:0xf bank_mask:0xf
    v_dot2c_f32_bf16_dpp v13, v27, v195 row_newbcast:0 row_mask:0xf bank_mask:0xf
    v_dot2c_f32_bf16_dpp v6, v24, v196 row_newbcast:4 row_mask:0xf bank_mask:0xf
    v_dot2c_f32_bf16_dpp v7, v26, v196 row_newbcast:4 row_mask:0xf bank_mask:0xf
    v_dot2c_f32_bf16_dpp v8, v24, v197 row_newbcast:4 row_mask:0xf bank_mask:0xf
    v_dot2c_f32_bf16_dpp v9, v26, v197 row_newbcast:4 row_mask:0xf bank_mask:0xf
    v_dot2c_f32_bf16_dpp v10, v24, v198 row_newbcast:4 row_mask:0xf bank_mask:0xf
    v_dot2c_f32_bf16_dpp v11, v26, v198 row_newbcast:4 row_mask:0xf bank_mask:0xf
    v_dot2c_f32_bf16_dpp v12, v24, v199 row_newbcast:4 row_mask:0xf bank_mask:0xf
    v_dot2c_f32_bf16_dpp v13, v26, v199 row_newbcast:4 row_mask:0xf bank_mask:0xf
    v_dot2c_f32_bf16_dpp v6, v25, v200 row_newbcast:4 row_mask:0xf bank_mask:0xf
    v_dot2c_f32_bf16_dpp v7, v27, v200 row_newbcast:4 row_mask:0xf bank_mask:0xf
    v_dot2c_f32_bf16_dpp v8, v25, v201 row_newbcast:4 row_mask:0xf bank_mask:0xf
    v_dot2c_f32_bf16_dpp v9, v27, v201 row_newbcast:4 row_mask:0xf bank_mask:0xf
    v_dot2c_f32_bf16_dpp v10, v25, v202 row_newbcast:4 row_mask:0xf bank_mask:0xf
    v_dot2c_f32_bf16_dpp v11, v27, v202 row_newbcast:4 row_mask:0xf bank_mask:0xf
    v_dot2c_f32_bf16_dpp v12, v25, v203 row_newbcast:4 row_mask:0xf bank_mask:0xf
    v_dot2c_f32_bf16_dpp v13, v27, v203 row_newbcast:4 row_mask:0xf bank_mask:0xf
    v_dot2c_f32_bf16_dpp v6, v24, v204 row_newbcast:8 row_mask:0xf bank_mask:0xf
    v_dot2c_f32_bf16_dpp v7, v26, v204 row_newbcast:8 row_mask:0xf bank_mask:0xf
    v_dot2c_f32_bf16_dpp v8, v24, v205 row_newbcast:8 row_mask:0xf bank_mask:0xf
    v_dot2c_f32_bf16_dpp v9, v26, v205 row_newbcast:8 row_mask:0xf bank_mask:0xf
    v_dot2c_f32_bf16_dpp v10, v24, v206 row_newbcast:8 row_mask:0xf bank_mask:0xf
    v_dot2c_f32_bf16_dpp v11, v26, v206 row_newbcast:8 row_mask:0xf bank_mask:0xf
    v_dot2c_f32_bf16_dpp v12, v24, v207 row_newbcast:8 row_mask:0xf bank_mask:0xf
    v_dot2c_f32_bf16_dpp v13, v26, v207 row_newbcast:8 row_mask:0xf bank_mask:0xf
    v_dot2c_f32_bf16_dpp v6, v25, v208 row_newbcast:8 row_mask:0xf bank_mask:0xf
    v_dot2c_f32_bf16_dpp v7, v27, v208 row_newbcast:8 row_mask:0xf bank_mask:0xf
    v_dot2c_f32_bf16_dpp v8, v25, v209 row_newbcast:8 row_mask:0xf bank_mask:0xf
    v_dot2c_f32_bf16_dpp v9, v27, v209 row_newbcast:8 row_mask:0xf bank_mask:0xf
    v_dot2c_f32_bf16_dpp v10, v25, v210 row_newbcast:8 row_mask:0xf bank_mask:0xf
    v_dot2c_f32_bf16_dpp v11, v27, v210 row_newbcast:8 row_mask:0xf bank_mask:0xf
    v_dot2c_f32_bf16_dpp v12, v25, v211 row_newbcast:8 row_mask:0xf bank_mask:0xf
    v_dot2c_f32_bf16_dpp v13, v27, v211 row_newbcast:8 row_mask:0xf bank_mask:0xf
    v_dot2c_f32_bf16_dpp v6, v24, v212 row_newbcast:12 row_mask:0xf bank_mask:0xf
    v_dot2c_f32_bf16_dpp v7, v26, v212 row_newbcast:12 row_mask:0xf bank_mask:0xf
    v_dot2c_f32_bf16_dpp v8, v24, v213 row_newbcast:12 row_mask:0xf bank_mask:0xf
    v_dot2c_f32_bf16_dpp v9, v26, v213 row_newbcast:12 row_mask:0xf bank_mask:0xf
    v_dot2c_f32_bf16_dpp v10, v24, v214 row_newbcast:12 row_mask:0xf bank_mask:0xf
    v_dot2c_f32_bf16_dpp v11, v26, v214 row_newbcast:12 row_mask:0xf bank_mask:0xf
    v_dot2c_f32_bf16_dpp v12, v24, v215 row_newbcast:12 row_mask:0xf bank_mask:0xf
    v_dot2c_f32_bf16_dpp v13, v26, v215 row_newbcast:12 row_mask:0xf bank_mask:0xf
    v_dot2c_f32_bf16_dpp v6, v25, v216 row_newbcast:12 row_mask:0xf bank_mask:0xf
    v_dot2c_f32_bf16_dpp v7, v27, v216 row_newbcast:12 row_mask:0xf bank_mask:0xf
    v_dot2c_f32_bf16_dpp v8, v25, v217 row_newbcast:12 row_mask:0xf bank_mask:0xf
    v_dot2c_f32_bf16_dpp v9, v27, v217 row_newbcast:12 row_mask:0xf bank_mask:0xf
    v_dot2c_f32_bf16_dpp v10, v25, v218 row_newbcast:12 row_mask:0xf bank_mask:0xf
    v_dot2c_f32_bf16_dpp v11, v27, v218 row_newbcast:12 row_mask:0xf bank_mask:0xf
    v_dot2c_f32_bf16_dpp v12, v25, v219 row_newbcast:12 row_mask:0xf bank_mask:0xf
    v_dot2c_f32_bf16_dpp v13, v27, v219 row_newbcast:12 row_mask:0xf bank_mask:0xf
    s_cmp_eq_u32 s27, 3
    s_cbranch_scc1 norefv_49
    s_add_u32 s34, s30, 8192
    buffer_load_dwordx4 v[188:191], v0, s[8:11], s34 offen offset:0 nt
    buffer_load_dwordx4 v[192:195], v0, s[8:11], s34 offen offset:1024 nt
    buffer_load_dwordx4 v[196:199], v0, s[8:11], s34 offen offset:2048 nt
    buffer_load_dwordx4 v[200:203], v0, s[8:11], s34 offen offset:3072 nt
    s_add_u32 s34, s30, 12288
    buffer_load_dwordx4 v[204:207], v0, s[8:11], s34 offen offset:0 nt
    buffer_load_dwordx4 v[208:211], v0, s[8:11], s34 offen offset:1024 nt
    buffer_load_dwordx4 v[212:215], v0, s[8:11], s34 offen offset:2048 nt
    buffer_load_dwordx4 v[216:219], v0, s[8:11], s34 offen offset:3072 nt
norefv_49:
    s_nop 3
    v_dot2_f32_bf16 v16, v92, v2, 0
    v_dot2_f32_bf16 v17, v96, v2, 0
    v_dot2_f32_bf16 v18, v100, v2, 0
    v_dot2_f32_bf16 v19, v104, v2, 0
    v_dot2_f32_bf16 v20, v108, v2, 0
    v_dot2_f32_bf16 v21, v112, v2, 0
    v_dot2_f32_bf16 v22, v116, v2, 0
    v_dot2_f32_bf16 v23, v120, v2, 0
    v_dot2_f32_bf16 v16, v93, v3, v16
    v_dot2_f32_bf16 v17, v97, v3, v17
    v_dot2_f32_bf16 v18, v101, v3, v18
    v_dot2_f32_bf16 v19, v105, v3, v19
    v_dot2_f32_bf16 v20, v109, v3, v20
    v_dot2_f32_bf16 v21, v113, v3, v21
    v_dot2_f32_bf16 v22, v117, v3, v22
    v_dot2_f32_bf16 v23, v121, v3, v23
    v_dot2_f32_bf16 v16, v94, v4, v16
    v_dot2_f32_bf16 v17, v98, v4, v17
    v_dot2_f32_bf16 v18, v102, v4, v18
    v_dot2_f32_bf16 v19, v106, v4, v19
    v_dot2_f32_bf16 v20, v110, v4, v20
    v_dot2_f32_bf16 v21, v114, v4, v21
    v_dot2_f32_bf16 v22, v118, v4, v22
    v_dot2_f32_bf16 v23, v122, v4, v23
    v_dot2_f32_bf16 v16, v95, v5, v16
    v_dot2_f32_bf16 v17, v99, v5, v17
    v_dot2_f32_bf16 v18, v103, v5, v18
    v_dot2_f32_bf16 v19, v107, v5, v19
    v_dot2_f32_bf16 v20, v111, v5, v20
    v_dot2_f32_bf16 v21, v115, v5, v21
    v_dot2_f32_bf16 v22, v119, v5, v22
    v_dot2_f32_bf16 v23, v123, v5, v23
    s_cmp_eq_u32 s27, 3
    s_cbranch_scc1 norefk_50
    s_add_u32 s34, s30, 16384
    buffer_load_dwordx4 v[92:95], v0, s[4:7], s34 offen offset:0 nt
    buffer_load_dwordx4 v[96:99], v0, s[4:7], s34 offen offset:1024 nt
    buffer_load_dwordx4 v[100:103], v0, s[4:7], s34 offen offset:2048 nt
    buffer_load_dwordx4 v[104:107], v0, s[4:7], s34 offen offset:3072 nt
    s_add_u32 s34, s30, 20480
    buffer_load_dwordx4 v[108:111], v0, s[4:7], s34 offen offset:0 nt
    buffer_load_dwordx4 v[112:115], v0, s[4:7], s34 offen offset:1024 nt
    buffer_load_dwordx4 v[116:119], v0, s[4:7], s34 offen offset:2048 nt
    buffer_load_dwordx4 v[120:123], v0, s[4:7], s34 offen offset:3072 nt
norefk_50:
    s_nop 3
    v_add_f32_dpp v16, v16, v16 row_mirror row_mask:0xf bank_mask:0x3
    v_add_f32_dpp v16, v20, v20 row_mirror row_mask:0xf bank_mask:0xc
    v_add_f32_dpp v17, v17, v17 row_mirror row_mask:0xf bank_mask:0x3
    v_add_f32_dpp v17, v21, v21 row_mirror row_mask:0xf bank_mask:0xc
    v_add_f32_dpp v18, v18, v18 row_mirror row_mask:0xf bank_mask:0x3
    v_add_f32_dpp v18, v22, v22 row_mirror row_mask:0xf bank_mask:0xc
    v_add_f32_dpp v19, v19, v19 row_mirror row_mask:0xf bank_mask:0x3
    v_add_f32_dpp v19, v23, v23 row_mirror row_mask:0xf bank_mask:0xc
    v_add_f32_dpp v16, v16, v16 row_half_mirror row_mask:0xf bank_mask:0x5
    v_add_f32_dpp v16, v18, v18 row_half_mirror row_mask:0xf bank_mask:0xa
    v_add_f32_dpp v17, v17, v17 row_half_mirror row_mask:0xf bank_mask:0x5
    v_add_f32_dpp v17, v19, v19 row_half_mirror row_mask:0xf bank_mask:0xa
    v_add_f32_dpp v16, v16, v16 quad_perm:[2,3,0,1] row_mask:0xf bank_mask:0xf
    s_nop 0
    v_add_f32_dpp v17, v17, v17 quad_perm:[2,3,0,1] row_mask:0xf bank_mask:0xf
    v_add_f32_dpp v16, v16, v16 quad_perm:[1,0,3,2] row_mask:0xf bank_mask:0xf
    s_nop 0
    v_add_f32_dpp v17, v17, v17 quad_perm:[1,0,3,2] row_mask:0xf bank_mask:0xf
    v_cvt_pk_bf16_f32 v18, v16, v17
    v_lshlrev_b32 v16, 16, v18
    v_and_b32 v17, 0xffff0000, v18
    v_mul_f32 v16, 0x3db504f3, v16
    v_mul_f32 v17, 0x3db504f3, v17
    v_cvt_pk_bf16_f32 v18, v16, v17
    v_lshlrev_b32 v16, 16, v18
    v_and_b32 v17, 0xffff0000, v18
    v_max_f32 v18, v16, v17
    s_nop 1
    v_max_f32_dpp v18, v18, v18 row_half_mirror row_mask:0xf bank_mask:0xf
    s_nop 1
    v_max_f32_dpp v18, v18, v18 row_mirror row_mask:0xf bank_mask:0xf
    v_max_f32 v18, v18, v14
    v_sub_f32 v19, v14, v18
    v_sub_f32 v16, v16, v18
    v_sub_f32 v17, v17, v18
    v_mul_f32 v19, 0x3fb8aa3b, v19
    v_mul_f32 v16, 0x3fb8aa3b, v16
    v_mul_f32 v17, 0x3fb8aa3b, v17
    v_exp_f32 v19, v19
    v_exp_f32 v16, v16
    v_exp_f32 v17, v17
    v_mov_b32 v14, v18
    v_cvt_pk_bf16_f32 v24, v16, 0
    v_cvt_pk_bf16_f32 v25, v17, 0
    v_fma_f32 v15, v15, v19, v16
    v_lshlrev_b32 v26, 16, v24
    v_lshlrev_b32 v27, 16, v25
    v_add_f32 v15, v15, v17
    v_mul_f32 v6, v6, v19
    v_mul_f32 v7, v7, v19
    v_mul_f32 v8, v8, v19
    v_mul_f32 v9, v9, v19
    v_mul_f32 v10, v10, v19
    v_mul_f32 v11, v11, v19
    v_mul_f32 v12, v12, v19
    v_mul_f32 v13, v13, v19
    v_dot2c_f32_bf16_dpp v6, v24, v220 row_newbcast:0 row_mask:0xf bank_mask:0xf
    v_dot2c_f32_bf16_dpp v7, v26, v220 row_newbcast:0 row_mask:0xf bank_mask:0xf
    v_dot2c_f32_bf16_dpp v8, v24, v221 row_newbcast:0 row_mask:0xf bank_mask:0xf
    v_dot2c_f32_bf16_dpp v9, v26, v221 row_newbcast:0 row_mask:0xf bank_mask:0xf
    v_dot2c_f32_bf16_dpp v10, v24, v222 row_newbcast:0 row_mask:0xf bank_mask:0xf
    v_dot2c_f32_bf16_dpp v11, v26, v222 row_newbcast:0 row_mask:0xf bank_mask:0xf
    v_dot2c_f32_bf16_dpp v12, v24, v223 row_newbcast:0 row_mask:0xf bank_mask:0xf
    v_dot2c_f32_bf16_dpp v13, v26, v223 row_newbcast:0 row_mask:0xf bank_mask:0xf
    v_dot2c_f32_bf16_dpp v6, v25, v224 row_newbcast:0 row_mask:0xf bank_mask:0xf
    v_dot2c_f32_bf16_dpp v7, v27, v224 row_newbcast:0 row_mask:0xf bank_mask:0xf
    v_dot2c_f32_bf16_dpp v8, v25, v225 row_newbcast:0 row_mask:0xf bank_mask:0xf
    v_dot2c_f32_bf16_dpp v9, v27, v225 row_newbcast:0 row_mask:0xf bank_mask:0xf
    v_dot2c_f32_bf16_dpp v10, v25, v226 row_newbcast:0 row_mask:0xf bank_mask:0xf
    v_dot2c_f32_bf16_dpp v11, v27, v226 row_newbcast:0 row_mask:0xf bank_mask:0xf
    v_dot2c_f32_bf16_dpp v12, v25, v227 row_newbcast:0 row_mask:0xf bank_mask:0xf
    v_dot2c_f32_bf16_dpp v13, v27, v227 row_newbcast:0 row_mask:0xf bank_mask:0xf
    v_dot2c_f32_bf16_dpp v6, v24, v228 row_newbcast:4 row_mask:0xf bank_mask:0xf
    v_dot2c_f32_bf16_dpp v7, v26, v228 row_newbcast:4 row_mask:0xf bank_mask:0xf
    v_dot2c_f32_bf16_dpp v8, v24, v229 row_newbcast:4 row_mask:0xf bank_mask:0xf
    v_dot2c_f32_bf16_dpp v9, v26, v229 row_newbcast:4 row_mask:0xf bank_mask:0xf
    v_dot2c_f32_bf16_dpp v10, v24, v230 row_newbcast:4 row_mask:0xf bank_mask:0xf
    v_dot2c_f32_bf16_dpp v11, v26, v230 row_newbcast:4 row_mask:0xf bank_mask:0xf
    v_dot2c_f32_bf16_dpp v12, v24, v231 row_newbcast:4 row_mask:0xf bank_mask:0xf
    v_dot2c_f32_bf16_dpp v13, v26, v231 row_newbcast:4 row_mask:0xf bank_mask:0xf
    v_dot2c_f32_bf16_dpp v6, v25, v232 row_newbcast:4 row_mask:0xf bank_mask:0xf
    v_dot2c_f32_bf16_dpp v7, v27, v232 row_newbcast:4 row_mask:0xf bank_mask:0xf
    v_dot2c_f32_bf16_dpp v8, v25, v233 row_newbcast:4 row_mask:0xf bank_mask:0xf
    v_dot2c_f32_bf16_dpp v9, v27, v233 row_newbcast:4 row_mask:0xf bank_mask:0xf
    v_dot2c_f32_bf16_dpp v10, v25, v234 row_newbcast:4 row_mask:0xf bank_mask:0xf
    v_dot2c_f32_bf16_dpp v11, v27, v234 row_newbcast:4 row_mask:0xf bank_mask:0xf
    v_dot2c_f32_bf16_dpp v12, v25, v235 row_newbcast:4 row_mask:0xf bank_mask:0xf
    v_dot2c_f32_bf16_dpp v13, v27, v235 row_newbcast:4 row_mask:0xf bank_mask:0xf
    v_dot2c_f32_bf16_dpp v6, v24, v236 row_newbcast:8 row_mask:0xf bank_mask:0xf
    v_dot2c_f32_bf16_dpp v7, v26, v236 row_newbcast:8 row_mask:0xf bank_mask:0xf
    v_dot2c_f32_bf16_dpp v8, v24, v237 row_newbcast:8 row_mask:0xf bank_mask:0xf
    v_dot2c_f32_bf16_dpp v9, v26, v237 row_newbcast:8 row_mask:0xf bank_mask:0xf
    v_dot2c_f32_bf16_dpp v10, v24, v238 row_newbcast:8 row_mask:0xf bank_mask:0xf
    v_dot2c_f32_bf16_dpp v11, v26, v238 row_newbcast:8 row_mask:0xf bank_mask:0xf
    v_dot2c_f32_bf16_dpp v12, v24, v239 row_newbcast:8 row_mask:0xf bank_mask:0xf
    v_dot2c_f32_bf16_dpp v13, v26, v239 row_newbcast:8 row_mask:0xf bank_mask:0xf
    v_dot2c_f32_bf16_dpp v6, v25, v240 row_newbcast:8 row_mask:0xf bank_mask:0xf
    v_dot2c_f32_bf16_dpp v7, v27, v240 row_newbcast:8 row_mask:0xf bank_mask:0xf
    v_dot2c_f32_bf16_dpp v8, v25, v241 row_newbcast:8 row_mask:0xf bank_mask:0xf
    v_dot2c_f32_bf16_dpp v9, v27, v241 row_newbcast:8 row_mask:0xf bank_mask:0xf
    v_dot2c_f32_bf16_dpp v10, v25, v242 row_newbcast:8 row_mask:0xf bank_mask:0xf
    v_dot2c_f32_bf16_dpp v11, v27, v242 row_newbcast:8 row_mask:0xf bank_mask:0xf
    v_dot2c_f32_bf16_dpp v12, v25, v243 row_newbcast:8 row_mask:0xf bank_mask:0xf
    v_dot2c_f32_bf16_dpp v13, v27, v243 row_newbcast:8 row_mask:0xf bank_mask:0xf
    v_dot2c_f32_bf16_dpp v6, v24, v244 row_newbcast:12 row_mask:0xf bank_mask:0xf
    v_dot2c_f32_bf16_dpp v7, v26, v244 row_newbcast:12 row_mask:0xf bank_mask:0xf
    v_dot2c_f32_bf16_dpp v8, v24, v245 row_newbcast:12 row_mask:0xf bank_mask:0xf
    v_dot2c_f32_bf16_dpp v9, v26, v245 row_newbcast:12 row_mask:0xf bank_mask:0xf
    v_dot2c_f32_bf16_dpp v10, v24, v246 row_newbcast:12 row_mask:0xf bank_mask:0xf
    v_dot2c_f32_bf16_dpp v11, v26, v246 row_newbcast:12 row_mask:0xf bank_mask:0xf
    v_dot2c_f32_bf16_dpp v12, v24, v247 row_newbcast:12 row_mask:0xf bank_mask:0xf
    v_dot2c_f32_bf16_dpp v13, v26, v247 row_newbcast:12 row_mask:0xf bank_mask:0xf
    v_dot2c_f32_bf16_dpp v6, v25, v248 row_newbcast:12 row_mask:0xf bank_mask:0xf
    v_dot2c_f32_bf16_dpp v7, v27, v248 row_newbcast:12 row_mask:0xf bank_mask:0xf
    v_dot2c_f32_bf16_dpp v8, v25, v249 row_newbcast:12 row_mask:0xf bank_mask:0xf
    v_dot2c_f32_bf16_dpp v9, v27, v249 row_newbcast:12 row_mask:0xf bank_mask:0xf
    v_dot2c_f32_bf16_dpp v10, v25, v250 row_newbcast:12 row_mask:0xf bank_mask:0xf
    v_dot2c_f32_bf16_dpp v11, v27, v250 row_newbcast:12 row_mask:0xf bank_mask:0xf
    v_dot2c_f32_bf16_dpp v12, v25, v251 row_newbcast:12 row_mask:0xf bank_mask:0xf
    v_dot2c_f32_bf16_dpp v13, v27, v251 row_newbcast:12 row_mask:0xf bank_mask:0xf
    s_cmp_eq_u32 s27, 3
    s_cbranch_scc1 norefv_51
    s_add_u32 s34, s30, 16384
    buffer_load_dwordx4 v[220:223], v0, s[8:11], s34 offen offset:0 nt
    buffer_load_dwordx4 v[224:227], v0, s[8:11], s34 offen offset:1024 nt
    buffer_load_dwordx4 v[228:231], v0, s[8:11], s34 offen offset:2048 nt
    buffer_load_dwordx4 v[232:235], v0, s[8:11], s34 offen offset:3072 nt
    s_add_u32 s34, s30, 20480
    buffer_load_dwordx4 v[236:239], v0, s[8:11], s34 offen offset:0 nt
    buffer_load_dwordx4 v[240:243], v0, s[8:11], s34 offen offset:1024 nt
    buffer_load_dwordx4 v[244:247], v0, s[8:11], s34 offen offset:2048 nt
    buffer_load_dwordx4 v[248:251], v0, s[8:11], s34 offen offset:3072 nt
norefv_51:
    s_nop 3
    v_dot2_f32_bf16 v16, v124, v2, 0
    v_dot2_f32_bf16 v17, v128, v2, 0
    v_dot2_f32_bf16 v18, v132, v2, 0
    v_dot2_f32_bf16 v19, v136, v2, 0
    v_dot2_f32_bf16 v20, v140, v2, 0
    v_dot2_f32_bf16 v21, v144, v2, 0
    v_dot2_f32_bf16 v22, v148, v2, 0
    v_dot2_f32_bf16 v23, v152, v2, 0
    v_dot2_f32_bf16 v16, v125, v3, v16
    v_dot2_f32_bf16 v17, v129, v3, v17
    v_dot2_f32_bf16 v18, v133, v3, v18
    v_dot2_f32_bf16 v19, v137, v3, v19
    v_dot2_f32_bf16 v20, v141, v3, v20
    v_dot2_f32_bf16 v21, v145, v3, v21
    v_dot2_f32_bf16 v22, v149, v3, v22
    v_dot2_f32_bf16 v23, v153, v3, v23
    v_dot2_f32_bf16 v16, v126, v4, v16
    v_dot2_f32_bf16 v17, v130, v4, v17
    v_dot2_f32_bf16 v18, v134, v4, v18
    v_dot2_f32_bf16 v19, v138, v4, v19
    v_dot2_f32_bf16 v20, v142, v4, v20
    v_dot2_f32_bf16 v21, v146, v4, v21
    v_dot2_f32_bf16 v22, v150, v4, v22
    v_dot2_f32_bf16 v23, v154, v4, v23
    v_dot2_f32_bf16 v16, v127, v5, v16
    v_dot2_f32_bf16 v17, v131, v5, v17
    v_dot2_f32_bf16 v18, v135, v5, v18
    v_dot2_f32_bf16 v19, v139, v5, v19
    v_dot2_f32_bf16 v20, v143, v5, v20
    v_dot2_f32_bf16 v21, v147, v5, v21
    v_dot2_f32_bf16 v22, v151, v5, v22
    v_dot2_f32_bf16 v23, v155, v5, v23
    v_add_f32_dpp v16, v16, v16 row_mirror row_mask:0xf bank_mask:0x3
    v_add_f32_dpp v16, v20, v20 row_mirror row_mask:0xf bank_mask:0xc
    v_add_f32_dpp v17, v17, v17 row_mirror row_mask:0xf bank_mask:0x3
    v_add_f32_dpp v17, v21, v21 row_mirror row_mask:0xf bank_mask:0xc
    v_add_f32_dpp v18, v18, v18 row_mirror row_mask:0xf bank_mask:0x3
    v_add_f32_dpp v18, v22, v22 row_mirror row_mask:0xf bank_mask:0xc
    v_add_f32_dpp v19, v19, v19 row_mirror row_mask:0xf bank_mask:0x3
    v_add_f32_dpp v19, v23, v23 row_mirror row_mask:0xf bank_mask:0xc
    v_add_f32_dpp v16, v16, v16 row_half_mirror row_mask:0xf bank_mask:0x5
    v_add_f32_dpp v16, v18, v18 row_half_mirror row_mask:0xf bank_mask:0xa
    v_add_f32_dpp v17, v17, v17 row_half_mirror row_mask:0xf bank_mask:0x5
    v_add_f32_dpp v17, v19, v19 row_half_mirror row_mask:0xf bank_mask:0xa
    v_add_f32_dpp v16, v16, v16 quad_perm:[2,3,0,1] row_mask:0xf bank_mask:0xf
    s_nop 0
    v_add_f32_dpp v17, v17, v17 quad_perm:[2,3,0,1] row_mask:0xf bank_mask:0xf
    v_add_f32_dpp v16, v16, v16 quad_perm:[1,0,3,2] row_mask:0xf bank_mask:0xf
    s_nop 0
    v_add_f32_dpp v17, v17, v17 quad_perm:[1,0,3,2] row_mask:0xf bank_mask:0xf
    v_cvt_pk_bf16_f32 v18, v16, v17
    v_lshlrev_b32 v16, 16, v18
    v_and_b32 v17, 0xffff0000, v18
    v_mul_f32 v16, 0x3db504f3, v16
    v_mul_f32 v17, 0x3db504f3, v17
    v_cvt_pk_bf16_f32 v18, v16, v17
    v_lshlrev_b32 v16, 16, v18
    v_and_b32 v17, 0xffff0000, v18
    v_max_f32 v18, v16, v17
    s_nop 1
    v_max_f32_dpp v18, v18, v18 row_half_mirror row_mask:0xf bank_mask:0xf
    s_nop 1
    v_max_f32_dpp v18, v18, v18 row_mirror row_mask:0xf bank_mask:0xf
    v_max_f32 v18, v18, v14
    v_sub_f32 v19, v14, v18
    v_sub_f32 v16, v16, v18
    v_sub_f32 v17, v17, v18
    v_mul_f32 v19, 0x3fb8aa3b, v19
    v_mul_f32 v16, 0x3fb8aa3b, v16
    v_mul_f32 v17, 0x3fb8aa3b, v17
    v_exp_f32 v19, v19
    v_exp_f32 v16, v16
    v_exp_f32 v17, v17
    v_mov_b32 v14, v18
    v_cvt_pk_bf16_f32 v24, v16, 0
    v_cvt_pk_bf16_f32 v25, v17, 0
    v_fma_f32 v15, v15, v19, v16
    v_lshlrev_b32 v26, 16, v24
    v_lshlrev_b32 v27, 16, v25
    v_add_f32 v15, v15, v17
    v_mul_f32 v6, v6, v19
    v_mul_f32 v7, v7, v19
    v_mul_f32 v8, v8, v19
    v_mul_f32 v9, v9, v19
    v_mul_f32 v10, v10, v19
    v_mul_f32 v11, v11, v19
    v_mul_f32 v12, v12, v19
    v_mul_f32 v13, v13, v19
    v_dot2c_f32_bf16_dpp v6, v24, v252 row_newbcast:0 row_mask:0xf bank_mask:0xf
    v_dot2c_f32_bf16_dpp v7, v26, v252 row_newbcast:0 row_mask:0xf bank_mask:0xf
    v_dot2c_f32_bf16_dpp v8, v24, v253 row_newbcast:0 row_mask:0xf bank_mask:0xf
    v_dot2c_f32_bf16_dpp v9, v26, v253 row_newbcast:0 row_mask:0xf bank_mask:0xf
    v_dot2c_f32_bf16_dpp v10, v24, v254 row_newbcast:0 row_mask:0xf bank_mask:0xf
    v_dot2c_f32_bf16_dpp v11, v26, v254 row_newbcast:0 row_mask:0xf bank_mask:0xf
    v_dot2c_f32_bf16_dpp v12, v24, v255 row_newbcast:0 row_mask:0xf bank_mask:0xf
    v_dot2c_f32_bf16_dpp v13, v26, v255 row_newbcast:0 row_mask:0xf bank_mask:0xf
    ds_read_b128 v[18:21], v1 offset:0
    s_waitcnt lgkmcnt(0)
    v_dot2c_f32_bf16_dpp v6, v25, v18 row_newbcast:0 row_mask:0xf bank_mask:0xf
    v_dot2c_f32_bf16_dpp v7, v27, v18 row_newbcast:0 row_mask:0xf bank_mask:0xf
    v_dot2c_f32_bf16_dpp v8, v25, v19 row_newbcast:0 row_mask:0xf bank_mask:0xf
    v_dot2c_f32_bf16_dpp v9, v27, v19 row_newbcast:0 row_mask:0xf bank_mask:0xf
    v_dot2c_f32_bf16_dpp v10, v25, v20 row_newbcast:0 row_mask:0xf bank_mask:0xf
    v_dot2c_f32_bf16_dpp v11, v27, v20 row_newbcast:0 row_mask:0xf bank_mask:0xf
    v_dot2c_f32_bf16_dpp v12, v25, v21 row_newbcast:0 row_mask:0xf bank_mask:0xf
    v_dot2c_f32_bf16_dpp v13, v27, v21 row_newbcast:0 row_mask:0xf bank_mask:0xf
    ds_read_b128 v[18:21], v1 offset:1024
    s_waitcnt lgkmcnt(0)
    v_dot2c_f32_bf16_dpp v6, v24, v18 row_newbcast:4 row_mask:0xf bank_mask:0xf
    v_dot2c_f32_bf16_dpp v7, v26, v18 row_newbcast:4 row_mask:0xf bank_mask:0xf
    v_dot2c_f32_bf16_dpp v8, v24, v19 row_newbcast:4 row_mask:0xf bank_mask:0xf
    v_dot2c_f32_bf16_dpp v9, v26, v19 row_newbcast:4 row_mask:0xf bank_mask:0xf
    v_dot2c_f32_bf16_dpp v10, v24, v20 row_newbcast:4 row_mask:0xf bank_mask:0xf
    v_dot2c_f32_bf16_dpp v11, v26, v20 row_newbcast:4 row_mask:0xf bank_mask:0xf
    v_dot2c_f32_bf16_dpp v12, v24, v21 row_newbcast:4 row_mask:0xf bank_mask:0xf
    v_dot2c_f32_bf16_dpp v13, v26, v21 row_newbcast:4 row_mask:0xf bank_mask:0xf
    ds_read_b128 v[18:21], v1 offset:2048
    s_waitcnt lgkmcnt(0)
    v_dot2c_f32_bf16_dpp v6, v25, v18 row_newbcast:4 row_mask:0xf bank_mask:0xf
    v_dot2c_f32_bf16_dpp v7, v27, v18 row_newbcast:4 row_mask:0xf bank_mask:0xf
    v_dot2c_f32_bf16_dpp v8, v25, v19 row_newbcast:4 row_mask:0xf bank_mask:0xf
    v_dot2c_f32_bf16_dpp v9, v27, v19 row_newbcast:4 row_mask:0xf bank_mask:0xf
    v_dot2c_f32_bf16_dpp v10, v25, v20 row_newbcast:4 row_mask:0xf bank_mask:0xf
    v_dot2c_f32_bf16_dpp v11, v27, v20 row_newbcast:4 row_mask:0xf bank_mask:0xf
    v_dot2c_f32_bf16_dpp v12, v25, v21 row_newbcast:4 row_mask:0xf bank_mask:0xf
    v_dot2c_f32_bf16_dpp v13, v27, v21 row_newbcast:4 row_mask:0xf bank_mask:0xf
    ds_read_b128 v[18:21], v1 offset:3072
    s_waitcnt lgkmcnt(0)
    v_dot2c_f32_bf16_dpp v6, v24, v18 row_newbcast:8 row_mask:0xf bank_mask:0xf
    v_dot2c_f32_bf16_dpp v7, v26, v18 row_newbcast:8 row_mask:0xf bank_mask:0xf
    v_dot2c_f32_bf16_dpp v8, v24, v19 row_newbcast:8 row_mask:0xf bank_mask:0xf
    v_dot2c_f32_bf16_dpp v9, v26, v19 row_newbcast:8 row_mask:0xf bank_mask:0xf
    v_dot2c_f32_bf16_dpp v10, v24, v20 row_newbcast:8 row_mask:0xf bank_mask:0xf
    v_dot2c_f32_bf16_dpp v11, v26, v20 row_newbcast:8 row_mask:0xf bank_mask:0xf
    v_dot2c_f32_bf16_dpp v12, v24, v21 row_newbcast:8 row_mask:0xf bank_mask:0xf
    v_dot2c_f32_bf16_dpp v13, v26, v21 row_newbcast:8 row_mask:0xf bank_mask:0xf
    ds_read_b128 v[18:21], v1 offset:4096
    s_waitcnt lgkmcnt(0)
    v_dot2c_f32_bf16_dpp v6, v25, v18 row_newbcast:8 row_mask:0xf bank_mask:0xf
    v_dot2c_f32_bf16_dpp v7, v27, v18 row_newbcast:8 row_mask:0xf bank_mask:0xf
    v_dot2c_f32_bf16_dpp v8, v25, v19 row_newbcast:8 row_mask:0xf bank_mask:0xf
    v_dot2c_f32_bf16_dpp v9, v27, v19 row_newbcast:8 row_mask:0xf bank_mask:0xf
    v_dot2c_f32_bf16_dpp v10, v25, v20 row_newbcast:8 row_mask:0xf bank_mask:0xf
    v_dot2c_f32_bf16_dpp v11, v27, v20 row_newbcast:8 row_mask:0xf bank_mask:0xf
    v_dot2c_f32_bf16_dpp v12, v25, v21 row_newbcast:8 row_mask:0xf bank_mask:0xf
    v_dot2c_f32_bf16_dpp v13, v27, v21 row_newbcast:8 row_mask:0xf bank_mask:0xf
    ds_read_b128 v[18:21], v1 offset:5120
    s_waitcnt lgkmcnt(0)
    v_dot2c_f32_bf16_dpp v6, v24, v18 row_newbcast:12 row_mask:0xf bank_mask:0xf
    v_dot2c_f32_bf16_dpp v7, v26, v18 row_newbcast:12 row_mask:0xf bank_mask:0xf
    v_dot2c_f32_bf16_dpp v8, v24, v19 row_newbcast:12 row_mask:0xf bank_mask:0xf
    v_dot2c_f32_bf16_dpp v9, v26, v19 row_newbcast:12 row_mask:0xf bank_mask:0xf
    v_dot2c_f32_bf16_dpp v10, v24, v20 row_newbcast:12 row_mask:0xf bank_mask:0xf
    v_dot2c_f32_bf16_dpp v11, v26, v20 row_newbcast:12 row_mask:0xf bank_mask:0xf
    v_dot2c_f32_bf16_dpp v12, v24, v21 row_newbcast:12 row_mask:0xf bank_mask:0xf
    v_dot2c_f32_bf16_dpp v13, v26, v21 row_newbcast:12 row_mask:0xf bank_mask:0xf
    ds_read_b128 v[18:21], v1 offset:6144
    s_waitcnt lgkmcnt(0)
    v_dot2c_f32_bf16_dpp v6, v25, v18 row_newbcast:12 row_mask:0xf bank_mask:0xf
    v_dot2c_f32_bf16_dpp v7, v27, v18 row_newbcast:12 row_mask:0xf bank_mask:0xf
    v_dot2c_f32_bf16_dpp v8, v25, v19 row_newbcast:12 row_mask:0xf bank_mask:0xf
    v_dot2c_f32_bf16_dpp v9, v27, v19 row_newbcast:12 row_mask:0xf bank_mask:0xf
    v_dot2c_f32_bf16_dpp v10, v25, v20 row_newbcast:12 row_mask:0xf bank_mask:0xf
    v_dot2c_f32_bf16_dpp v11, v27, v20 row_newbcast:12 row_mask:0xf bank_mask:0xf
    v_dot2c_f32_bf16_dpp v12, v25, v21 row_newbcast:12 row_mask:0xf bank_mask:0xf
    v_dot2c_f32_bf16_dpp v13, v27, v21 row_newbcast:12 row_mask:0xf bank_mask:0xf
    v_mov_b32 v16, v14
    v_mov_b32 v17, v14
    s_nop 1
    v_permlane16_swap_b32 v16, v17
    v_max_f32 v16, v16, v17
    v_mov_b32 v17, v16
    s_nop 1
    v_permlane32_swap_b32 v16, v17
    v_max_f32 v16, v16, v17
    v_sub_f32 v17, v14, v16
    v_mul_f32 v17, 0x3fb8aa3b, v17
    v_exp_f32 v17, v17
    s_nop 0
    v_mul_f32 v15, v15, v17
    v_mul_f32 v6, v6, v17
    v_mul_f32 v7, v7, v17
    v_mul_f32 v8, v8, v17
    v_mul_f32 v9, v9, v17
    v_mul_f32 v10, v10, v17
    v_mul_f32 v11, v11, v17
    v_mul_f32 v12, v12, v17
    v_mul_f32 v13, v13, v17
    v_add_f32_dpp v15, v15, v15 row_half_mirror row_mask:0xf bank_mask:0xf
    s_nop 1
    v_add_f32_dpp v15, v15, v15 row_mirror row_mask:0xf bank_mask:0xf
    v_mov_b32 v17, v15
    s_nop 1
    v_permlane16_swap_b32 v15, v17
    v_add_f32 v15, v15, v17
    v_mov_b32 v17, v15
    s_nop 1
    v_permlane32_swap_b32 v15, v17
    v_add_f32 v15, v15, v17
    v_permlane32_swap_b32 v6, v10
    v_permlane32_swap_b32 v7, v11
    v_permlane32_swap_b32 v8, v12
    v_permlane32_swap_b32 v9, v13
    v_add_f32 v6, v6, v10
    v_add_f32 v7, v7, v11
    v_add_f32 v8, v8, v12
    v_add_f32 v9, v9, v13
    s_nop 0
    v_permlane16_swap_b32 v6, v8
    v_permlane16_swap_b32 v7, v9
    v_add_f32 v6, v6, v8
    v_add_f32 v7, v7, v9
    v_mbcnt_lo_u32_b32 v18, -1, 0
    v_mbcnt_hi_u32_b32 v18, -1, v18
    v_and_b32 v19, 15, v18
    v_lshlrev_b32 v19, 5, v19
    v_lshrrev_b32 v17, 4, v18
    v_lshl_add_u32 v19, v17, 3, v19
    s_lshl_b32 s32, s24, 9
    s_add_u32 s32, s32, 152064
    v_add_u32 v19, s32, v19
    ds_write_b64 v19, v[6:7]
    v_mov_b32 v8, v16
    v_mov_b32 v9, v15
    s_lshl_b32 s32, s24, 3
    s_add_u32 s32, s32, 156160
    v_mov_b32 v19, s32
    ds_write_b64 v19, v[8:9]
    s_waitcnt lgkmcnt(0)
    s_barrier
    s_cmp_ge_u32 s24, 2
    s_cbranch_scc1 ep_skip_52
    v_mbcnt_lo_u32_b32 v26, -1, 0
    v_mbcnt_hi_u32_b32 v26, -1, v26
    s_lshl_b32 s32, s24, 8
    s_add_u32 s32, s32, 152064
    v_lshlrev_b32 v26, 2, v26
    v_add_u32 v26, s32, v26
    v_mov_b32 v27, 156160
    ds_read_b32 v2, v26 offset:0
    ds_read_b32 v3, v26 offset:512
    ds_read_b32 v4, v26 offset:1024
    ds_read_b32 v5, v26 offset:1536
    ds_read_b32 v6, v26 offset:2048
    ds_read_b32 v7, v26 offset:2560
    ds_read_b32 v8, v26 offset:3072
    ds_read_b32 v9, v26 offset:3584
    ds_read_b128 v[10:13], v27 offset:0
    ds_read_b128 v[14:17], v27 offset:16
    ds_read_b128 v[18:21], v27 offset:32
    ds_read_b128 v[22:25], v27 offset:48
    s_waitcnt lgkmcnt(0)
    v_max3_f32 v26, v10, v12, v14
    v_max3_f32 v26, v26, v16, v18
    v_max3_f32 v26, v26, v20, v22
    v_max_f32 v26, v26, v24
    v_sub_f32 v10, v10, v26
    v_sub_f32 v12, v12, v26
    v_sub_f32 v14, v14, v26
    v_sub_f32 v16, v16, v26
    v_sub_f32 v18, v18, v26
    v_sub_f32 v20, v20, v26
    v_sub_f32 v22, v22, v26
    v_sub_f32 v24, v24, v26
    v_mul_f32 v10, 0x3fb8aa3b, v10
    v_mul_f32 v12, 0x3fb8aa3b, v12
    v_mul_f32 v14, 0x3fb8aa3b, v14
    v_mul_f32 v16, 0x3fb8aa3b, v16
    v_mul_f32 v18, 0x3fb8aa3b, v18
    v_mul_f32 v20, 0x3fb8aa3b, v20
    v_mul_f32 v22, 0x3fb8aa3b, v22
    v_mul_f32 v24, 0x3fb8aa3b, v24
    v_exp_f32 v10, v10
    v_exp_f32 v12, v12
    v_exp_f32 v14, v14
    v_exp_f32 v16, v16
    v_exp_f32 v18, v18
    v_exp_f32 v20, v20
    v_exp_f32 v22, v22
    v_exp_f32 v24, v24
    v_mul_f32 v2, v2, v10
    v_mul_f32 v27, v11, v10
    v_fma_f32 v2, v3, v12, v2
    v_fma_f32 v27, v13, v12, v27
    v_fma_f32 v2, v4, v14, v2
    v_fma_f32 v27, v15, v14, v27
    v_fma_f32 v2, v5, v16, v2
    v_fma_f32 v27, v17, v16, v27
    v_fma_f32 v2, v6, v18, v2
    v_fma_f32 v27, v19, v18, v27
    v_fma_f32 v2, v7, v20, v2
    v_fma_f32 v27, v21, v20, v27
    v_fma_f32 v2, v8, v22, v2
    v_fma_f32 v27, v23, v22, v27
    v_fma_f32 v2, v9, v24, v2
    v_fma_f32 v27, v25, v24, v27
    v_mbcnt_lo_u32_b32 v3, -1, 0
    v_mbcnt_hi_u32_b32 v3, -1, v3
    v_lshlrev_b32 v4, 2, v3
    s_mul_i32 s32, s21, 576
    s_add_u32 s32, s32, s53
    s_lshl_b32 s33, s24, 8
    s_add_u32 s33, s33, s32
    buffer_store_dword v2, v4, s[12:15], s33 offen offset:0
    s_cmp_lg_u32 s24, 0
    s_cbranch_scc1 ep_skip_52
    v_cmp_eq_u32 vcc, 0, v3
    s_and_saveexec_b64 s[36:37], vcc
    buffer_store_dwordx2 v[26:27], v4, s[12:15], s32 offen offset:512
    s_mov_b64 exec, -1
ep_skip_52:
    s_nop 3
    s_add_u32 s27, s27, 1
    s_branch step_loop
main_bail:
main_end:
    s_endpgm
.section .rodata,"a"
.p2align 6
.amdhsa_kernel interleave_layers__gqa_block_cached__dense_activation_silu__decode_kernel
  .amdhsa_next_free_vgpr 256
  .amdhsa_next_free_sgpr 100
  .amdhsa_accum_offset 256
  .amdhsa_group_segment_fixed_size 0
  .amdhsa_kernarg_size 88
  .amdhsa_user_sgpr_count 2
  .amdhsa_user_sgpr_kernarg_segment_ptr 1
  .amdhsa_system_sgpr_workgroup_id_x 1
.end_amdhsa_kernel
.text
```
